```python
import torch

def _softmax(x, axis=-1):
    return torch.softmax(x, dim=axis)

def _gelu(x):
    return torch.nn.functional.gelu(x, approximate='tanh')

def _silu(x):
    return torch.nn.functional.silu(x)

def _sigmoid(x):
    return torch.sigmoid(x)

def _layernorm(x, axis=-1, eps=1e-05):
    m = x.mean(dim=axis, keepdim=True)
    v = x.var(dim=axis, keepdim=True, unbiased=False)
    return (x - m) / torch.sqrt(v + eps)

def _scatter_add(tgt, idx, src, axis=0):
    return tgt.clone().index_add_(axis, idx, src)

def _segment_sum(src, seg, n):
    out = torch.zeros((n,) + src.shape[1:], dtype=src.dtype)
    return out.index_add_(0, seg, src)

def _pad(x, pw):
    flat = tuple((v for pair in reversed(pw) for v in pair))
    return torch.nn.functional.pad(x, flat)
kernel_name = 'gated_mix__memory_aug_recurrent_mem_tr__dense_activation_gelu__prompt'

def setup_inputs():

    _w = lambda a: (lambda t: t.to(torch.bfloat16) if t.is_floating_point() else t)(torch.as_tensor(a))

    def _A_setup():
        B, S, Dm = (1, 2048, 512)
        H, Dh = (32, 128)
        M, seg = (8, 32)
        seg = min(seg, S)
        S = S // seg * seg
        return {'x': _w((lambda *s: torch.randn(*s, dtype=torch.bfloat16) * 0.05)(B, S, Dm)), 'mem0': _w((lambda *s: torch.randn(*s, dtype=torch.bfloat16) * 0.4)(B, M, Dm)), 'Wq': _w((lambda *s: torch.randn(*s, dtype=torch.bfloat16) * 6.4)(Dm, H, Dh) * Dm ** (-0.5)), 'Wk': _w((lambda *s: torch.randn(*s, dtype=torch.bfloat16) * 6.4)(Dm, H, Dh) * Dm ** (-0.5)), 'Wv': _w((lambda *s: torch.randn(*s, dtype=torch.bfloat16) * 0.4)(Dm, H, Dh) * Dm ** (-0.5)), 'Wo': _w((lambda *s: torch.randn(*s, dtype=torch.bfloat16) * 0.4)(H, Dh, Dm) * (H * Dh) ** (-0.5)), 'seg_len': seg}
    _A_in = _A_setup()

    def _B_setup():
        B, S, D, F = (1, 2048, 512, 1376)
        return {'x': _w((lambda *s: torch.randn(*s, dtype=torch.bfloat16) * 0.05)(B, S, D)), 'w1': _w((lambda *s: torch.randn(*s, dtype=torch.bfloat16) * 3.2)(D, F) * D ** (-0.5)), 'b1': _w((lambda *s: torch.randn(*s, dtype=torch.bfloat16) * 3.2)(F) * 0.01), 'w2': _w((lambda *s: torch.randn(*s, dtype=torch.bfloat16) * 0.2)(F, D) * F ** (-0.5)), 'b2': _w((lambda *s: torch.randn(*s, dtype=torch.bfloat16) * 0.4)(D) * 0.01)}
    _B_in = _B_setup()
    return {'A_x': _A_in['x'], 'A_mem0': _A_in['mem0'], 'A_Wq': _A_in['Wq'], 'A_Wk': _A_in['Wk'], 'A_Wv': _A_in['Wv'], 'A_Wo': _A_in['Wo'], 'A_seg_len': _A_in['seg_len'], 'B_x': _B_in['x'], 'B_w1': _B_in['w1'], 'B_b1': _B_in['b1'], 'B_w2': _B_in['w2'], 'B_b2': _B_in['b2'], 'gate_w': _w((lambda *s: torch.randn(*s, dtype=torch.bfloat16) * 0.05)(512) * 16.0)}

def reference(A_x, A_mem0, A_Wq, A_Wk, A_Wv, A_Wo, A_seg_len, B_x, B_w1, B_b1, B_w2, B_b2, gate_w):

    def _A_ref(x, mem0, Wq, Wk, Wv, Wo, seg_len):
        B, S, Dm = x.shape
        H, Dh = (Wq.shape[1], Wq.shape[2])
        M = mem0.shape[1]
        scale = Dh ** (-0.5)
        n_seg = S // seg_len
        L = M + seg_len
        idx = torch.arange(L)
        mask = (idx[:, None] < M) | (idx[:, None] >= idx[None, :])
        mem = mem0
        outs = []
        for s in range(n_seg):
            xs = x[:, s * seg_len:(s + 1) * seg_len, :].clone()
            h = torch.concatenate([mem, xs], axis=1)
            q = torch.einsum('btd,dhe->bhte', h, Wq)
            k = torch.einsum('btd,dhe->bhte', h, Wk)
            v = torch.einsum('btd,dhe->bhte', h, Wv)
            scores = torch.einsum('bhqe,bhke->bhqk', q, k) * scale
            scores = torch.where(mask[None, None], scores, -1000000000.0)
            p = _softmax(scores, axis=-1)
            o = torch.einsum('bhqk,bhke->bhqe', p, v)
            o = torch.einsum('bhte,hed->btd', o, Wo)
            mem = o[:, :M, :].clone()
            outs.append(o[:, M:, :])
        return torch.concatenate(outs, axis=1)

    def _B_ref(x, w1, b1, w2, b2):
        h = torch.einsum('bsd,df->bsf', x, w1) + b1
        h = _gelu(h)
        return torch.einsum('bsf,fd->bsd', h, w2) + b2
    x = A_x
    g = _sigmoid((x * gate_w).sum(-1, keepdims=True))
    a = _A_ref(x, A_mem0, A_Wq, A_Wk, A_Wv, A_Wo, A_seg_len)
    b = _B_ref(x, B_w1, B_b1, B_w2, B_b2)
    return g * a + (1 - g) * b
```

```asm
; @launch grid=(256,1,1) block=(256,1,1) lds=163840
.amdgcn_target "amdgcn-amd-amdhsa--gfx950"
.text
.globl gated_mix__memory_aug_recurrent_mem_tr__dense_activation_gelu__prompt_kernel
.p2align 8
.type gated_mix__memory_aug_recurrent_mem_tr__dense_activation_gelu__prompt_kernel,@function
gated_mix__memory_aug_recurrent_mem_tr__dense_activation_gelu__prompt_kernel:
    s_cmp_ge_u32 s2, 256
    s_cbranch_scc1 L_end
    s_load_dwordx16 s[32:47], s[0:1], 0
    s_load_dwordx16 s[48:63], s[0:1], 64
    s_getreg_b32 s3, hwreg(HW_REG_XCC_ID, 0, 4)
    v_lshrrev_b32 v2, 6, v0
    v_and_b32 v3, 63, v0
    v_readfirstlane_b32 s64, v2
    v_lshlrev_b32 v1, 4, v3
    s_getpc_b64 s[4:5]
L_pc:
    s_bfe_u32 s6, s2, 0x20003
    s_lshl_b32 s6, s6, 2
    s_add_u32 s6, s6, s64
    s_lshl_b32 s6, s6, 13
    v_lshlrev_b32 v98, 7, v3
    v_add_u32 v98, s6, v98
    v_min_u32 v98, L_last - L_pc, v98
    v_mov_b32 v99, s5
    v_add_co_u32 v98, vcc, s4, v98
    s_nop 1
    v_addc_co_u32 v99, vcc, 0, v99, vcc
    s_min_u32 s3, s3, 7
    s_and_b32 s4, s3, 3
    s_lshl_b32 s4, s4, 6
    s_lshr_b32 s5, s3, 2
    s_lshl_b32 s5, s5, 2
    s_add_u32 s4, s4, s5
    v_mov_b32 v40, 0x80000000
    v_mov_b32 v41, s4
    v_cmp_eq_u32 vcc, 0, v0
    s_nop 1
    v_cndmask_b32 v42, v40, v41, vcc
    v_add_u32 v31, 8, v42
    v_mov_b32 v44, 1
    v_mov_b32 v12, -1
    v_mov_b32 v13, -1
    v_mov_b32 v14, -1
    v_mov_b32 v15, -1
    s_lshl_b32 s5, s2, 12
    v_lshlrev_b32 v30, 4, v0
    v_add_u32 v30, s5, v30
    s_mov_b32 s28, 2097152
    s_mov_b32 s67, 0
    s_waitcnt lgkmcnt(0)
    s_mov_b32 s24, s60
    s_and_b32 s25, s61, 0xffff
    s_mov_b32 s26, 0x100
    s_mov_b32 s27, 0x20000
    buffer_atomic_add v44, v42, s[24:27], 0 offen sc0
    global_load_dword v100, v[98:99], off
    s_mov_b32 s8, s62
    s_and_b32 s9, s63, 0xffff
    s_mov_b32 s10, 0x10000000
    s_mov_b32 s11, 0x20000
    s_mov_b32 s12, s32
    s_and_b32 s13, s33, 0xffff
    s_mov_b32 s14, 0x200000
    s_mov_b32 s15, 0x20000
    s_mov_b32 s20, s58
    s_and_b32 s21, s59, 0xffff
    s_mov_b32 s22, 0x200000
    s_mov_b32 s23, 0x20000
    s_mov_b32 s68, s36
    s_and_b32 s69, s37, 0xffff
    s_mov_b32 s70, 0x400000
    s_mov_b32 s71, 0x20000
    s_mov_b32 s72, s38
    s_and_b32 s73, s39, 0xffff
    s_mov_b32 s74, 0x400000
    s_mov_b32 s75, 0x20000
    s_mov_b32 s76, s40
    s_and_b32 s77, s41, 0xffff
    s_mov_b32 s78, 0x400000
    s_mov_b32 s79, 0x20000
    s_mov_b32 s80, s42
    s_and_b32 s81, s43, 0xffff
    s_mov_b32 s82, 0x400000
    s_mov_b32 s83, 0x20000
    s_mov_b32 s84, s48
    s_and_b32 s85, s49, 0xffff
    s_mov_b32 s86, 0x158000
    s_mov_b32 s87, 0x20000
    s_mov_b32 s88, s52
    s_and_b32 s89, s53, 0xffff
    s_mov_b32 s90, 0x158000
    s_mov_b32 s91, 0x20000
    v_mov_b32 v46, 0x27a04
    v_mov_b32 v47, 0x27a00
    v_cndmask_b32 v46, v46, v47, vcc
    s_waitcnt vmcnt(1)
    ds_write_b32 v46, v44
    s_waitcnt lgkmcnt(0)
    s_barrier
    ds_read_b32 v48, v47
    s_waitcnt lgkmcnt(0)
    v_readfirstlane_b32 s4, v48
    s_lshl_b32 s5, s3, 5
    s_add_u32 s67, s5, s4
    s_cmp_lt_u32 s4, 32
    s_cbranch_scc1 L_have_slot
    v_lshlrev_b32 v49, 2, v3
L_ovf_poll:
    buffer_load_dword v48, v49, s[24:27], 0 offen sc1
    s_waitcnt vmcnt(0)
    v_readlane_b32 s92, v48, 0
    v_readlane_b32 s93, v48, 16
    v_readlane_b32 s94, v48, 32
    v_readlane_b32 s95, v48, 48
    v_readlane_b32 s96, v48, 1
    v_readlane_b32 s97, v48, 17
    v_readlane_b32 s98, v48, 33
    v_readlane_b32 s99, v48, 49
    s_add_u32 s5, s92, s93
    s_add_u32 s5, s5, s94
    s_add_u32 s5, s5, s95
    s_add_u32 s5, s5, s96
    s_add_u32 s5, s5, s97
    s_add_u32 s5, s5, s98
    s_add_u32 s5, s5, s99
    s_cmp_eq_u32 s5, 256
    s_cbranch_scc1 L_ovf_go
    s_sleep 2
    s_sub_u32 s28, s28, 1
    s_cbranch_scc1 L_fail
    s_branch L_ovf_poll
L_ovf_go:
    s_sub_u32 s4, s4, 32
    s_sub_i32 s5, s92, 32
    s_max_i32 s5, s5, 0
    s_cmp_gt_u32 s3, 0
    s_cselect_b32 s5, s5, 0
    s_add_u32 s4, s4, s5
    s_sub_i32 s5, s93, 32
    s_max_i32 s5, s5, 0
    s_cmp_gt_u32 s3, 1
    s_cselect_b32 s5, s5, 0
    s_add_u32 s4, s4, s5
    s_sub_i32 s5, s94, 32
    s_max_i32 s5, s5, 0
    s_cmp_gt_u32 s3, 2
    s_cselect_b32 s5, s5, 0
    s_add_u32 s4, s4, s5
    s_sub_i32 s5, s95, 32
    s_max_i32 s5, s5, 0
    s_cmp_gt_u32 s3, 3
    s_cselect_b32 s5, s5, 0
    s_add_u32 s4, s4, s5
    s_sub_i32 s5, s96, 32
    s_max_i32 s5, s5, 0
    s_cmp_gt_u32 s3, 4
    s_cselect_b32 s5, s5, 0
    s_add_u32 s4, s4, s5
    s_sub_i32 s5, s97, 32
    s_max_i32 s5, s5, 0
    s_cmp_gt_u32 s3, 5
    s_cselect_b32 s5, s5, 0
    s_add_u32 s4, s4, s5
    s_sub_i32 s5, s98, 32
    s_max_i32 s5, s5, 0
    s_cmp_gt_u32 s3, 6
    s_cselect_b32 s5, s5, 0
    s_add_u32 s4, s4, s5
    s_mov_b32 s67, 255
    s_mov_b32 s6, 0
    s_sub_i32 s5, 32, s92
    s_max_i32 s5, s5, 0
    s_sub_u32 s7, s4, s6
    s_cmp_lt_u32 s7, s5
    s_cselect_b32 s100, 1, 0
    s_add_u32 s7, s7, s92
    s_add_u32 s7, s7, 0
    s_cmp_eq_u32 s100, 1
    s_cselect_b32 s67, s7, s67
    s_add_u32 s6, s6, s5
    s_sub_i32 s5, 32, s93
    s_max_i32 s5, s5, 0
    s_sub_u32 s7, s4, s6
    s_cmp_lt_u32 s7, s5
    s_cselect_b32 s100, 1, 0
    s_add_u32 s7, s7, s93
    s_add_u32 s7, s7, 32
    s_cmp_eq_u32 s100, 1
    s_cselect_b32 s67, s7, s67
    s_add_u32 s6, s6, s5
    s_sub_i32 s5, 32, s94
    s_max_i32 s5, s5, 0
    s_sub_u32 s7, s4, s6
    s_cmp_lt_u32 s7, s5
    s_cselect_b32 s100, 1, 0
    s_add_u32 s7, s7, s94
    s_add_u32 s7, s7, 64
    s_cmp_eq_u32 s100, 1
    s_cselect_b32 s67, s7, s67
    s_add_u32 s6, s6, s5
    s_sub_i32 s5, 32, s95
    s_max_i32 s5, s5, 0
    s_sub_u32 s7, s4, s6
    s_cmp_lt_u32 s7, s5
    s_cselect_b32 s100, 1, 0
    s_add_u32 s7, s7, s95
    s_add_u32 s7, s7, 96
    s_cmp_eq_u32 s100, 1
    s_cselect_b32 s67, s7, s67
    s_add_u32 s6, s6, s5
    s_sub_i32 s5, 32, s96
    s_max_i32 s5, s5, 0
    s_sub_u32 s7, s4, s6
    s_cmp_lt_u32 s7, s5
    s_cselect_b32 s100, 1, 0
    s_add_u32 s7, s7, s96
    s_add_u32 s7, s7, 128
    s_cmp_eq_u32 s100, 1
    s_cselect_b32 s67, s7, s67
    s_add_u32 s6, s6, s5
    s_sub_i32 s5, 32, s97
    s_max_i32 s5, s5, 0
    s_sub_u32 s7, s4, s6
    s_cmp_lt_u32 s7, s5
    s_cselect_b32 s100, 1, 0
    s_add_u32 s7, s7, s97
    s_add_u32 s7, s7, 160
    s_cmp_eq_u32 s100, 1
    s_cselect_b32 s67, s7, s67
    s_add_u32 s6, s6, s5
    s_sub_i32 s5, 32, s98
    s_max_i32 s5, s5, 0
    s_sub_u32 s7, s4, s6
    s_cmp_lt_u32 s7, s5
    s_cselect_b32 s100, 1, 0
    s_add_u32 s7, s7, s98
    s_add_u32 s7, s7, 192
    s_cmp_eq_u32 s100, 1
    s_cselect_b32 s67, s7, s67
    s_add_u32 s6, s6, s5
    s_sub_i32 s5, 32, s99
    s_max_i32 s5, s5, 0
    s_sub_u32 s7, s4, s6
    s_cmp_lt_u32 s7, s5
    s_cselect_b32 s100, 1, 0
    s_add_u32 s7, s7, s99
    s_add_u32 s7, s7, 224
    s_cmp_eq_u32 s100, 1
    s_cselect_b32 s67, s7, s67
    s_add_u32 s6, s6, s5
L_have_slot:
    s_and_b32 s67, s67, 255
    s_sub_u32 s4, s67, 32
    s_mul_hi_u32 s5, s4, 0x24924925
    s_mul_i32 s6, s5, 7
    s_sub_u32 s66, s4, s6
    s_cmp_lt_u32 s67, 32
    s_cselect_b32 s65, s67, s5
    s_and_b32 s65, s65, 31
    v_lshrrev_b32 v34, 4, v3
    v_bfe_u32 v35, v3, 1, 3
    v_xor_b32 v35, v35, v34
    v_lshlrev_b32 v35, 5, v35
    v_and_b32 v36, 1, v3
    v_lshl_or_b32 v35, v36, 4, v35
    v_lshl_or_b32 v32, v34, 13, v35
    s_lshl_b32 s4, s65, 8
    v_add_u32 v32, s4, v32
    v_xor_b32 v33, 0x80, v32
    v_bfe_u32 v40, v3, 2, 2
    v_and_b32 v41, 1, v34
    v_lshl_or_b32 v41, v41, 2, v40
    v_lshl_add_u32 v42, v34, 3, v40
    v_and_b32 v43, 3, v3
    v_lshlrev_b32 v43, 3, v43
    v_lshl_or_b32 v42, v42, 8, v43
    s_lshl_b32 s4, s64, 1
    v_xor_b32 v36, s4, v41
    v_lshl_or_b32 v36, v36, 5, v42
    v_xor_b32 v37, 32, v36
    v_add_u32 v38, 0x10000, v36
    v_add_u32 v39, 0x10000, v37
    s_lshl_b32 s98, s64, 12
    s_lshl_b32 s99, s64, 17
    s_cmp_lt_u32 s67, 32
    s_cbranch_scc0 L_worker
    v_lshrrev_b32 v34, 4, v3
    v_and_b32 v50, 1, v34
    s_and_b32 s4, s64, 1
    s_lshl_b32 s4, s4, 2
    v_or_b32 v50, s4, v50
    v_bfe_u32 v51, v3, 1, 3
    v_xor_b32 v51, v51, v50
    v_lshlrev_b32 v51, 5, v51
    v_and_b32 v50, 1, v3
    v_lshl_or_b32 v51, v50, 4, v51
    v_lshl_or_b32 v106, v34, 10, v51
    s_lshl_b32 s4, s65, 17
    v_add_u32 v106, s4, v106
    v_xor_b32 v107, 64, v106
    s_lshl_b32 s100, s64, 14
    v_and_b32 v50, 1, v34
    v_lshlrev_b32 v50, 4, v50
    v_lshrrev_b32 v51, 1, v34
    v_lshl_or_b32 v50, v51, 3, v50
    v_bfe_u32 v51, v3, 3, 1
    v_lshl_or_b32 v50, v51, 2, v50
    v_bfe_u32 v51, v3, 2, 1
    v_or_b32 v50, v50, v51
    v_lshl_or_b32 v50, v50, 8, v43
    v_xor_b32 v108, s64, v41
    v_lshl_or_b32 v108, v108, 5, v50
    v_xor_b32 v109, 0x80, v108
    v_add_u32 v110, 0x10000, v108
    v_add_u32 v111, 0x10000, v109
    s_lshl_b32 s4, s64, 11
    v_add_u32 v112, s4, v1
    v_add_u32 v113, 0x10000, v112
    s_add_u32 s92, s99, 0x0
    s_add_u32 s93, s98, 0x0
    s_mov_b32 m0, s93
    s_nop 0
    buffer_load_dwordx4 v32, s[68:71], s92 offen lds
    s_add_u32 s92, s99, 0x8000
    s_add_u32 s93, s98, 0x400
    s_mov_b32 m0, s93
    s_nop 0
    buffer_load_dwordx4 v32, s[68:71], s92 offen lds
    s_add_u32 s92, s99, 0x10000
    s_add_u32 s93, s98, 0x800
    s_mov_b32 m0, s93
    s_nop 0
    buffer_load_dwordx4 v33, s[68:71], s92 offen lds
    s_add_u32 s92, s99, 0x18000
    s_add_u32 s93, s98, 0xc00
    s_mov_b32 m0, s93
    s_nop 0
    buffer_load_dwordx4 v33, s[68:71], s92 offen lds
    s_add_u32 s92, s99, 0x80000
    s_add_u32 s93, s98, 0x4000
    s_mov_b32 m0, s93
    s_nop 0
    buffer_load_dwordx4 v32, s[68:71], s92 offen lds
    s_add_u32 s92, s99, 0x88000
    s_add_u32 s93, s98, 0x4400
    s_mov_b32 m0, s93
    s_nop 0
    buffer_load_dwordx4 v32, s[68:71], s92 offen lds
    s_add_u32 s92, s99, 0x90000
    s_add_u32 s93, s98, 0x4800
    s_mov_b32 m0, s93
    s_nop 0
    buffer_load_dwordx4 v33, s[68:71], s92 offen lds
    s_add_u32 s92, s99, 0x98000
    s_add_u32 s93, s98, 0x4c00
    s_mov_b32 m0, s93
    s_nop 0
    buffer_load_dwordx4 v33, s[68:71], s92 offen lds
    s_add_u32 s92, s99, 0x100000
    s_add_u32 s93, s98, 0x8000
    s_mov_b32 m0, s93
    s_nop 0
    buffer_load_dwordx4 v32, s[68:71], s92 offen lds
    s_add_u32 s92, s99, 0x108000
    s_add_u32 s93, s98, 0x8400
    s_mov_b32 m0, s93
    s_nop 0
    buffer_load_dwordx4 v32, s[68:71], s92 offen lds
    s_add_u32 s92, s99, 0x110000
    s_add_u32 s93, s98, 0x8800
    s_mov_b32 m0, s93
    s_nop 0
    buffer_load_dwordx4 v33, s[68:71], s92 offen lds
    s_add_u32 s92, s99, 0x118000
    s_add_u32 s93, s98, 0x8c00
    s_mov_b32 m0, s93
    s_nop 0
    buffer_load_dwordx4 v33, s[68:71], s92 offen lds
    s_add_u32 s92, s99, 0x180000
    s_add_u32 s93, s98, 0xc000
    s_mov_b32 m0, s93
    s_nop 0
    buffer_load_dwordx4 v32, s[68:71], s92 offen lds
    s_add_u32 s92, s99, 0x188000
    s_add_u32 s93, s98, 0xc400
    s_mov_b32 m0, s93
    s_nop 0
    buffer_load_dwordx4 v32, s[68:71], s92 offen lds
    s_add_u32 s92, s99, 0x190000
    s_add_u32 s93, s98, 0xc800
    s_mov_b32 m0, s93
    s_nop 0
    buffer_load_dwordx4 v33, s[68:71], s92 offen lds
    s_add_u32 s92, s99, 0x198000
    s_add_u32 s93, s98, 0xcc00
    s_mov_b32 m0, s93
    s_nop 0
    buffer_load_dwordx4 v33, s[68:71], s92 offen lds
    s_add_u32 s92, s99, 0x200000
    s_add_u32 s93, s98, 0x10000
    s_mov_b32 m0, s93
    s_nop 0
    buffer_load_dwordx4 v32, s[68:71], s92 offen lds
    s_add_u32 s92, s99, 0x208000
    s_add_u32 s93, s98, 0x10400
    s_mov_b32 m0, s93
    s_nop 0
    buffer_load_dwordx4 v32, s[68:71], s92 offen lds
    s_add_u32 s92, s99, 0x210000
    s_add_u32 s93, s98, 0x10800
    s_mov_b32 m0, s93
    s_nop 0
    buffer_load_dwordx4 v33, s[68:71], s92 offen lds
    s_add_u32 s92, s99, 0x218000
    s_add_u32 s93, s98, 0x10c00
    s_mov_b32 m0, s93
    s_nop 0
    buffer_load_dwordx4 v33, s[68:71], s92 offen lds
    s_add_u32 s92, s99, 0x280000
    s_add_u32 s93, s98, 0x14000
    s_mov_b32 m0, s93
    s_nop 0
    buffer_load_dwordx4 v32, s[68:71], s92 offen lds
    s_add_u32 s92, s99, 0x288000
    s_add_u32 s93, s98, 0x14400
    s_mov_b32 m0, s93
    s_nop 0
    buffer_load_dwordx4 v32, s[68:71], s92 offen lds
    s_add_u32 s92, s99, 0x290000
    s_add_u32 s93, s98, 0x14800
    s_mov_b32 m0, s93
    s_nop 0
    buffer_load_dwordx4 v33, s[68:71], s92 offen lds
    s_add_u32 s92, s99, 0x298000
    s_add_u32 s93, s98, 0x14c00
    s_mov_b32 m0, s93
    s_nop 0
    buffer_load_dwordx4 v33, s[68:71], s92 offen lds
    s_add_u32 s92, s99, 0x300000
    s_add_u32 s93, s98, 0x18000
    s_mov_b32 m0, s93
    s_nop 0
    buffer_load_dwordx4 v32, s[68:71], s92 offen lds
    s_add_u32 s92, s99, 0x308000
    s_add_u32 s93, s98, 0x18400
    s_mov_b32 m0, s93
    s_nop 0
    buffer_load_dwordx4 v32, s[68:71], s92 offen lds
    s_add_u32 s92, s99, 0x310000
    s_add_u32 s93, s98, 0x18800
    s_mov_b32 m0, s93
    s_nop 0
    buffer_load_dwordx4 v33, s[68:71], s92 offen lds
    s_add_u32 s92, s99, 0x318000
    s_add_u32 s93, s98, 0x18c00
    s_mov_b32 m0, s93
    s_nop 0
    buffer_load_dwordx4 v33, s[68:71], s92 offen lds
    s_add_u32 s16, s62, 0x8000000
    s_addc_u32 s17, s63, 0
    s_and_b32 s17, s17, 0xffff
    s_mov_b32 s18, 0x1a6400
    s_mov_b32 s19, 0x20000
    s_mov_b32 s5, 0x100000
    buffer_store_dwordx4 v[12:15], v30, s[16:19], 0 offen sc1
    buffer_store_dwordx4 v[12:15], v30, s[16:19], s5 offen sc1
    s_nop 1
    v_mov_b32 v22, v112
    v_mov_b32 v23, v113
    v_and_b32 v50, 2, v3
    v_cmp_eq_u32 vcc, 0, v50
    v_mov_b32 v50, 0xeeee
    v_mov_b32 v51, 0x4444
    v_cndmask_b32 v2, v50, v51, vcc
    v_mov_b32 v8, 0x3f803f80
    v_mov_b32 v9, 0x3f803f80
    v_mov_b32 v10, 0x3f803f80
    v_mov_b32 v11, 0x3f803f80
    v_lshrrev_b32 v50, 4, v3
    v_mul_u32_u24 v50, 576, v50
    v_and_b32 v51, 15, v3
    v_lshl_add_u32 v50, v51, 2, v50
    s_lshl_b32 s4, s64, 6
    s_add_u32 s4, s4, 0x26000
    v_add_u32 v17, s4, v50
    v_lshrrev_b32 v52, 4, v3
    v_and_b32 v50, 7, v3
    v_mul_u32_u24 v50, 288, v50
    v_lshl_add_u32 v50, v52, 4, v50
    v_add_u32 v18, 0x26000, v50
    v_bfe_u32 v50, v3, 2, 2
    v_and_b32 v51, 1, v3
    v_lshl_add_u32 v50, v50, 1, v51
    v_mul_u32_u24 v50, 288, v50
    v_lshl_add_u32 v50, v52, 4, v50
    v_add_u32 v19, 0x26000, v50
    v_add_u32 v19, 2304, v19
    v_add_u32 v126, 2304, v17
    v_bfe_u32 v50, v3, 3, 1
    v_and_b32 v51, 3, v3
    v_lshl_add_u32 v50, v50, 1, v51
    v_bfe_u32 v52, v3, 2, 1
    v_lshlrev_b32 v52, 4, v52
    v_mov_b32 v53, 0x3f80
    v_lshlrev_b32 v53, v52, v53
    v_cmp_gt_u32 vcc, 2, v51
    s_nop 1
    v_cndmask_b32 v53, 0, v53, vcc
    v_cmp_eq_u32 vcc, 0, v50
    s_nop 1
    v_cndmask_b32 v4, 0, v53, vcc
    v_cmp_eq_u32 vcc, 1, v50
    s_nop 1
    v_cndmask_b32 v5, 0, v53, vcc
    v_cmp_eq_u32 vcc, 2, v50
    s_nop 1
    v_cndmask_b32 v6, 0, v53, vcc
    v_cmp_eq_u32 vcc, 3, v50
    s_nop 1
    v_cndmask_b32 v7, 0, v53, vcc
    v_add_u32 v21, 0x20000, v1
    v_lshlrev_b32 v24, 7, v3
    v_mov_b32 v121, 0
    v_mov_b32 v123, 0
    v_mov_b32 v125, 0
    v_mov_b32 v60, 0x80000000
    s_mul_i32 s4, s64, 73728
    s_mul_i32 s5, s65, 2304
    s_add_u32 s4, s4, s5
    s_add_u32 s4, s4, 0x8100000
    v_lshlrev_b32 v50, 2, v3
    v_add_u32 v13, s4, v50
    s_and_b32 s4, s65, 3
    s_mul_i32 s4, s4, 73728
    s_lshr_b32 s31, s65, 2
    s_lshl_b32 s5, s31, 8
    s_add_u32 s4, s4, s5
    s_and_b32 s6, s64, 1
    s_lshl_b32 s5, s6, 7
    s_add_u32 s4, s4, s5
    s_add_u32 s4, s4, 0x8100000
    v_lshrrev_b32 v50, 3, v3
    v_mul_u32_u24 v50, 2304, v50
    v_and_b32 v52, 7, v3
    v_lshl_add_u32 v50, v52, 4, v50
    v_add_u32 v14, s4, v50
    s_and_b32 s4, s31, 1
    s_lshr_b32 s5, s31, 2
    s_lshl_b32 s5, s5, 1
    s_add_u32 s4, s4, s5
    s_lshl_b32 s4, s4, 11
    s_lshr_b32 s5, s31, 1
    s_xor_b32 s5, s5, s31
    s_and_b32 s5, s5, 1
    s_lshl_b32 s5, s5, 10
    s_add_u32 s4, s4, s5
    s_and_b32 s5, s65, 3
    s_lshl_b32 s5, s5, 8
    s_add_u32 s4, s4, s5
    s_lshl_b32 s5, s6, 7
    s_add_u32 s4, s4, s5
    v_lshrrev_b32 v51, 4, v3
    v_and_b32 v52, 3, v3
    v_bfe_u32 v54, v3, 2, 1
    v_lshl_add_u32 v50, v54, 2, v51
    v_lshlrev_b32 v50, 4, v50
    v_lshl_or_b32 v50, v52, 2, v50
    v_add_u32 v50, s4, v50
    v_and_b32 v53, 0xffffff80, v50
    v_add_u32 v50, v50, v53
    v_and_b32 v53, 8, v3
    v_cmp_eq_u32 vcc, 0, v53
    s_cmp_ge_u32 s64, 2
    s_cselect_b64 vcc, vcc, 0
    v_cndmask_b32 v16, v60, v50, vcc
    v_and_b32 v53, 0x380, v1
    v_add_u32 v25, v53, v1
    v_and_b32 v50, 1, v51
    v_lshl_add_u32 v50, v54, 1, v50
    s_lshl_b32 s5, s6, 2
    v_add_u32 v50, s5, v50
    v_lshlrev_b32 v50, 10, v50
    v_lshl_or_b32 v50, v52, 3, v50
    v_lshrrev_b32 v53, 5, v3
    v_lshl_or_b32 v50, v53, 2, v50
    s_lshl_b32 s4, s65, 5
    v_add_u32 v50, s4, v50
    s_mov_b32 s16, s34
    s_and_b32 s17, s35, 0xffff
    s_mov_b32 s18, 0x2000
    s_mov_b32 s19, 0x20000
    buffer_load_dword v27, v50, s[16:19], 0 offen
    v_lshrrev_b32 v50, 5, v3
    v_lshlrev_b32 v50, 4, v50
    v_bfe_u32 v52, v3, 1, 2
    v_lshl_or_b32 v50, v52, 2, v50
    v_bfe_u32 v52, v3, 4, 1
    v_lshl_or_b32 v50, v52, 1, v50
    v_and_b32 v52, 1, v3
    v_or_b32 v50, v50, v52
    v_lshlrev_b32 v50, 4, v50
    s_lshl_b32 s4, s64, 9
    s_add_u32 s4, s4, 0x27200
    v_add_u32 v20, s4, v50
    v_and_b32 v50, 8, v3
    v_add_u32 v20, v50, v20
    s_waitcnt vmcnt(27)
    s_barrier
    s_add_u32 s92, s99, 0x380000
    s_add_u32 s93, s98, 0x1c000
    s_mov_b32 m0, s93
    s_nop 0
    buffer_load_dwordx4 v32, s[68:71], s92 offen lds
    s_add_u32 s92, s99, 0x388000
    s_add_u32 s93, s98, 0x1c400
    s_mov_b32 m0, s93
    s_nop 0
    buffer_load_dwordx4 v32, s[68:71], s92 offen lds
    s_add_u32 s92, s99, 0x390000
    s_add_u32 s93, s98, 0x1c800
    s_mov_b32 m0, s93
    s_nop 0
    buffer_load_dwordx4 v33, s[68:71], s92 offen lds
    s_add_u32 s92, s99, 0x398000
    s_add_u32 s93, s98, 0x1cc00
    s_mov_b32 m0, s93
    s_nop 0
    buffer_load_dwordx4 v33, s[68:71], s92 offen lds
    ds_read_b64_tr_b16 a[0:1], v36 offset:0
    ds_read_b64_tr_b16 a[2:3], v36 offset:1024
    ds_read_b64_tr_b16 a[4:5], v36 offset:8192
    ds_read_b64_tr_b16 a[6:7], v36 offset:9216
    ds_read_b64_tr_b16 a[64:65], v37 offset:0
    ds_read_b64_tr_b16 a[66:67], v37 offset:1024
    ds_read_b64_tr_b16 a[68:69], v37 offset:8192
    ds_read_b64_tr_b16 a[70:71], v37 offset:9216
    s_waitcnt lgkmcnt(0)
    s_waitcnt vmcnt(27)
    s_barrier
    s_add_u32 s92, s99, 0x0
    s_add_u32 s93, s98, 0x0
    s_mov_b32 m0, s93
    s_nop 0
    buffer_load_dwordx4 v32, s[72:75], s92 offen lds
    s_add_u32 s92, s99, 0x8000
    s_add_u32 s93, s98, 0x400
    s_mov_b32 m0, s93
    s_nop 0
    buffer_load_dwordx4 v32, s[72:75], s92 offen lds
    s_add_u32 s92, s99, 0x10000
    s_add_u32 s93, s98, 0x800
    s_mov_b32 m0, s93
    s_nop 0
    buffer_load_dwordx4 v33, s[72:75], s92 offen lds
    s_add_u32 s92, s99, 0x18000
    s_add_u32 s93, s98, 0xc00
    s_mov_b32 m0, s93
    s_nop 0
    buffer_load_dwordx4 v33, s[72:75], s92 offen lds
    ds_read_b64_tr_b16 a[8:9], v36 offset:16384
    ds_read_b64_tr_b16 a[10:11], v36 offset:17408
    ds_read_b64_tr_b16 a[12:13], v36 offset:24576
    ds_read_b64_tr_b16 a[14:15], v36 offset:25600
    ds_read_b64_tr_b16 a[72:73], v37 offset:16384
    ds_read_b64_tr_b16 a[74:75], v37 offset:17408
    ds_read_b64_tr_b16 a[76:77], v37 offset:24576
    ds_read_b64_tr_b16 a[78:79], v37 offset:25600
    s_waitcnt lgkmcnt(0)
    s_waitcnt vmcnt(27)
    s_barrier
    s_add_u32 s92, s99, 0x80000
    s_add_u32 s93, s98, 0x4000
    s_mov_b32 m0, s93
    s_nop 0
    buffer_load_dwordx4 v32, s[72:75], s92 offen lds
    s_add_u32 s92, s99, 0x88000
    s_add_u32 s93, s98, 0x4400
    s_mov_b32 m0, s93
    s_nop 0
    buffer_load_dwordx4 v32, s[72:75], s92 offen lds
    s_add_u32 s92, s99, 0x90000
    s_add_u32 s93, s98, 0x4800
    s_mov_b32 m0, s93
    s_nop 0
    buffer_load_dwordx4 v33, s[72:75], s92 offen lds
    s_add_u32 s92, s99, 0x98000
    s_add_u32 s93, s98, 0x4c00
    s_mov_b32 m0, s93
    s_nop 0
    buffer_load_dwordx4 v33, s[72:75], s92 offen lds
    ds_read_b64_tr_b16 a[16:17], v36 offset:32768
    ds_read_b64_tr_b16 a[18:19], v36 offset:33792
    ds_read_b64_tr_b16 a[20:21], v36 offset:40960
    ds_read_b64_tr_b16 a[22:23], v36 offset:41984
    ds_read_b64_tr_b16 a[80:81], v37 offset:32768
    ds_read_b64_tr_b16 a[82:83], v37 offset:33792
    ds_read_b64_tr_b16 a[84:85], v37 offset:40960
    ds_read_b64_tr_b16 a[86:87], v37 offset:41984
    s_waitcnt lgkmcnt(0)
    s_waitcnt vmcnt(27)
    s_barrier
    s_add_u32 s92, s99, 0x100000
    s_add_u32 s93, s98, 0x8000
    s_mov_b32 m0, s93
    s_nop 0
    buffer_load_dwordx4 v32, s[72:75], s92 offen lds
    s_add_u32 s92, s99, 0x108000
    s_add_u32 s93, s98, 0x8400
    s_mov_b32 m0, s93
    s_nop 0
    buffer_load_dwordx4 v32, s[72:75], s92 offen lds
    s_add_u32 s92, s99, 0x110000
    s_add_u32 s93, s98, 0x8800
    s_mov_b32 m0, s93
    s_nop 0
    buffer_load_dwordx4 v33, s[72:75], s92 offen lds
    s_add_u32 s92, s99, 0x118000
    s_add_u32 s93, s98, 0x8c00
    s_mov_b32 m0, s93
    s_nop 0
    buffer_load_dwordx4 v33, s[72:75], s92 offen lds
    ds_read_b64_tr_b16 a[24:25], v36 offset:49152
    ds_read_b64_tr_b16 a[26:27], v36 offset:50176
    ds_read_b64_tr_b16 a[28:29], v36 offset:57344
    ds_read_b64_tr_b16 a[30:31], v36 offset:58368
    ds_read_b64_tr_b16 a[88:89], v37 offset:49152
    ds_read_b64_tr_b16 a[90:91], v37 offset:50176
    ds_read_b64_tr_b16 a[92:93], v37 offset:57344
    ds_read_b64_tr_b16 a[94:95], v37 offset:58368
    s_waitcnt lgkmcnt(0)
    s_waitcnt vmcnt(27)
    s_barrier
    s_add_u32 s92, s99, 0x180000
    s_add_u32 s93, s98, 0xc000
    s_mov_b32 m0, s93
    s_nop 0
    buffer_load_dwordx4 v32, s[72:75], s92 offen lds
    s_add_u32 s92, s99, 0x188000
    s_add_u32 s93, s98, 0xc400
    s_mov_b32 m0, s93
    s_nop 0
    buffer_load_dwordx4 v32, s[72:75], s92 offen lds
    s_add_u32 s92, s99, 0x190000
    s_add_u32 s93, s98, 0xc800
    s_mov_b32 m0, s93
    s_nop 0
    buffer_load_dwordx4 v33, s[72:75], s92 offen lds
    s_add_u32 s92, s99, 0x198000
    s_add_u32 s93, s98, 0xcc00
    s_mov_b32 m0, s93
    s_nop 0
    buffer_load_dwordx4 v33, s[72:75], s92 offen lds
    ds_read_b64_tr_b16 a[32:33], v38 offset:0
    ds_read_b64_tr_b16 a[34:35], v38 offset:1024
    ds_read_b64_tr_b16 a[36:37], v38 offset:8192
    ds_read_b64_tr_b16 a[38:39], v38 offset:9216
    ds_read_b64_tr_b16 a[96:97], v39 offset:0
    ds_read_b64_tr_b16 a[98:99], v39 offset:1024
    ds_read_b64_tr_b16 a[100:101], v39 offset:8192
    ds_read_b64_tr_b16 a[102:103], v39 offset:9216
    s_waitcnt lgkmcnt(0)
    s_waitcnt vmcnt(27)
    s_barrier
    s_add_u32 s92, s99, 0x200000
    s_add_u32 s93, s98, 0x10000
    s_mov_b32 m0, s93
    s_nop 0
    buffer_load_dwordx4 v32, s[72:75], s92 offen lds
    s_add_u32 s92, s99, 0x208000
    s_add_u32 s93, s98, 0x10400
    s_mov_b32 m0, s93
    s_nop 0
    buffer_load_dwordx4 v32, s[72:75], s92 offen lds
    s_add_u32 s92, s99, 0x210000
    s_add_u32 s93, s98, 0x10800
    s_mov_b32 m0, s93
    s_nop 0
    buffer_load_dwordx4 v33, s[72:75], s92 offen lds
    s_add_u32 s92, s99, 0x218000
    s_add_u32 s93, s98, 0x10c00
    s_mov_b32 m0, s93
    s_nop 0
    buffer_load_dwordx4 v33, s[72:75], s92 offen lds
    ds_read_b64_tr_b16 a[40:41], v38 offset:16384
    ds_read_b64_tr_b16 a[42:43], v38 offset:17408
    ds_read_b64_tr_b16 a[44:45], v38 offset:24576
    ds_read_b64_tr_b16 a[46:47], v38 offset:25600
    ds_read_b64_tr_b16 a[104:105], v39 offset:16384
    ds_read_b64_tr_b16 a[106:107], v39 offset:17408
    ds_read_b64_tr_b16 a[108:109], v39 offset:24576
    ds_read_b64_tr_b16 a[110:111], v39 offset:25600
    s_waitcnt lgkmcnt(0)
    s_waitcnt vmcnt(27)
    s_barrier
    s_add_u32 s92, s99, 0x280000
    s_add_u32 s93, s98, 0x14000
    s_mov_b32 m0, s93
    s_nop 0
    buffer_load_dwordx4 v32, s[72:75], s92 offen lds
    s_add_u32 s92, s99, 0x288000
    s_add_u32 s93, s98, 0x14400
    s_mov_b32 m0, s93
    s_nop 0
    buffer_load_dwordx4 v32, s[72:75], s92 offen lds
    s_add_u32 s92, s99, 0x290000
    s_add_u32 s93, s98, 0x14800
    s_mov_b32 m0, s93
    s_nop 0
    buffer_load_dwordx4 v33, s[72:75], s92 offen lds
    s_add_u32 s92, s99, 0x298000
    s_add_u32 s93, s98, 0x14c00
    s_mov_b32 m0, s93
    s_nop 0
    buffer_load_dwordx4 v33, s[72:75], s92 offen lds
    ds_read_b64_tr_b16 a[48:49], v38 offset:32768
    ds_read_b64_tr_b16 a[50:51], v38 offset:33792
    ds_read_b64_tr_b16 a[52:53], v38 offset:40960
    ds_read_b64_tr_b16 a[54:55], v38 offset:41984
    ds_read_b64_tr_b16 a[112:113], v39 offset:32768
    ds_read_b64_tr_b16 a[114:115], v39 offset:33792
    ds_read_b64_tr_b16 a[116:117], v39 offset:40960
    ds_read_b64_tr_b16 a[118:119], v39 offset:41984
    s_waitcnt lgkmcnt(0)
    s_waitcnt vmcnt(24)
    s_barrier
    v_mov_b32 v44, 1
    buffer_atomic_add v44, v31, s[24:27], 0 offen
    s_add_u32 s92, s99, 0x300000
    s_add_u32 s93, s98, 0x18000
    s_mov_b32 m0, s93
    s_nop 0
    buffer_load_dwordx4 v32, s[72:75], s92 offen lds
    s_add_u32 s92, s99, 0x308000
    s_add_u32 s93, s98, 0x18400
    s_mov_b32 m0, s93
    s_nop 0
    buffer_load_dwordx4 v32, s[72:75], s92 offen lds
    s_add_u32 s92, s99, 0x310000
    s_add_u32 s93, s98, 0x18800
    s_mov_b32 m0, s93
    s_nop 0
    buffer_load_dwordx4 v33, s[72:75], s92 offen lds
    s_add_u32 s92, s99, 0x318000
    s_add_u32 s93, s98, 0x18c00
    s_mov_b32 m0, s93
    s_nop 0
    buffer_load_dwordx4 v33, s[72:75], s92 offen lds
    ds_read_b64_tr_b16 a[56:57], v38 offset:49152
    ds_read_b64_tr_b16 a[58:59], v38 offset:50176
    ds_read_b64_tr_b16 a[60:61], v38 offset:57344
    ds_read_b64_tr_b16 a[62:63], v38 offset:58368
    ds_read_b64_tr_b16 a[120:121], v39 offset:49152
    ds_read_b64_tr_b16 a[122:123], v39 offset:50176
    ds_read_b64_tr_b16 a[124:125], v39 offset:57344
    ds_read_b64_tr_b16 a[126:127], v39 offset:58368
    s_waitcnt lgkmcnt(0)
    s_waitcnt vmcnt(25)
    s_barrier
    s_add_u32 s92, s99, 0x380000
    s_add_u32 s93, s98, 0x1c000
    s_mov_b32 m0, s93
    s_nop 0
    buffer_load_dwordx4 v32, s[72:75], s92 offen lds
    s_add_u32 s92, s99, 0x388000
    s_add_u32 s93, s98, 0x1c400
    s_mov_b32 m0, s93
    s_nop 0
    buffer_load_dwordx4 v32, s[72:75], s92 offen lds
    s_add_u32 s92, s99, 0x390000
    s_add_u32 s93, s98, 0x1c800
    s_mov_b32 m0, s93
    s_nop 0
    buffer_load_dwordx4 v33, s[72:75], s92 offen lds
    s_add_u32 s92, s99, 0x398000
    s_add_u32 s93, s98, 0x1cc00
    s_mov_b32 m0, s93
    s_nop 0
    buffer_load_dwordx4 v33, s[72:75], s92 offen lds
    ds_read_b64_tr_b16 a[128:129], v36 offset:0
    ds_read_b64_tr_b16 a[130:131], v36 offset:1024
    ds_read_b64_tr_b16 a[132:133], v36 offset:8192
    ds_read_b64_tr_b16 a[134:135], v36 offset:9216
    ds_read_b64_tr_b16 a[192:193], v37 offset:0
    ds_read_b64_tr_b16 a[194:195], v37 offset:1024
    ds_read_b64_tr_b16 a[196:197], v37 offset:8192
    ds_read_b64_tr_b16 a[198:199], v37 offset:9216
    s_waitcnt lgkmcnt(0)
    s_waitcnt vmcnt(25)
    s_barrier
    s_add_u32 s92, s99, 0x0
    s_add_u32 s93, s98, 0x0
    s_mov_b32 m0, s93
    s_nop 0
    buffer_load_dwordx4 v32, s[76:79], s92 offen lds
    s_add_u32 s92, s99, 0x8000
    s_add_u32 s93, s98, 0x400
    s_mov_b32 m0, s93
    s_nop 0
    buffer_load_dwordx4 v32, s[76:79], s92 offen lds
    s_add_u32 s92, s99, 0x10000
    s_add_u32 s93, s98, 0x800
    s_mov_b32 m0, s93
    s_nop 0
    buffer_load_dwordx4 v33, s[76:79], s92 offen lds
    s_add_u32 s92, s99, 0x18000
    s_add_u32 s93, s98, 0xc00
    s_mov_b32 m0, s93
    s_nop 0
    buffer_load_dwordx4 v33, s[76:79], s92 offen lds
    ds_read_b64_tr_b16 a[136:137], v36 offset:16384
    ds_read_b64_tr_b16 a[138:139], v36 offset:17408
    ds_read_b64_tr_b16 a[140:141], v36 offset:24576
    ds_read_b64_tr_b16 a[142:143], v36 offset:25600
    ds_read_b64_tr_b16 a[200:201], v37 offset:16384
    ds_read_b64_tr_b16 a[202:203], v37 offset:17408
    ds_read_b64_tr_b16 a[204:205], v37 offset:24576
    ds_read_b64_tr_b16 a[206:207], v37 offset:25600
    s_waitcnt lgkmcnt(0)
    s_waitcnt vmcnt(25)
    s_barrier
    s_add_u32 s92, s99, 0x80000
    s_add_u32 s93, s98, 0x4000
    s_mov_b32 m0, s93
    s_nop 0
    buffer_load_dwordx4 v32, s[76:79], s92 offen lds
    s_add_u32 s92, s99, 0x88000
    s_add_u32 s93, s98, 0x4400
    s_mov_b32 m0, s93
    s_nop 0
    buffer_load_dwordx4 v32, s[76:79], s92 offen lds
    s_add_u32 s92, s99, 0x90000
    s_add_u32 s93, s98, 0x4800
    s_mov_b32 m0, s93
    s_nop 0
    buffer_load_dwordx4 v33, s[76:79], s92 offen lds
    s_add_u32 s92, s99, 0x98000
    s_add_u32 s93, s98, 0x4c00
    s_mov_b32 m0, s93
    s_nop 0
    buffer_load_dwordx4 v33, s[76:79], s92 offen lds
    ds_read_b64_tr_b16 a[144:145], v36 offset:32768
    ds_read_b64_tr_b16 a[146:147], v36 offset:33792
    ds_read_b64_tr_b16 a[148:149], v36 offset:40960
    ds_read_b64_tr_b16 a[150:151], v36 offset:41984
    ds_read_b64_tr_b16 a[208:209], v37 offset:32768
    ds_read_b64_tr_b16 a[210:211], v37 offset:33792
    ds_read_b64_tr_b16 a[212:213], v37 offset:40960
    ds_read_b64_tr_b16 a[214:215], v37 offset:41984
    s_waitcnt lgkmcnt(0)
    s_waitcnt vmcnt(25)
    s_barrier
    s_add_u32 s92, s99, 0x100000
    s_add_u32 s93, s98, 0x8000
    s_mov_b32 m0, s93
    s_nop 0
    buffer_load_dwordx4 v32, s[76:79], s92 offen lds
    s_add_u32 s92, s99, 0x108000
    s_add_u32 s93, s98, 0x8400
    s_mov_b32 m0, s93
    s_nop 0
    buffer_load_dwordx4 v32, s[76:79], s92 offen lds
    s_add_u32 s92, s99, 0x110000
    s_add_u32 s93, s98, 0x8800
    s_mov_b32 m0, s93
    s_nop 0
    buffer_load_dwordx4 v33, s[76:79], s92 offen lds
    s_add_u32 s92, s99, 0x118000
    s_add_u32 s93, s98, 0x8c00
    s_mov_b32 m0, s93
    s_nop 0
    buffer_load_dwordx4 v33, s[76:79], s92 offen lds
    ds_read_b64_tr_b16 a[152:153], v36 offset:49152
    ds_read_b64_tr_b16 a[154:155], v36 offset:50176
    ds_read_b64_tr_b16 a[156:157], v36 offset:57344
    ds_read_b64_tr_b16 a[158:159], v36 offset:58368
    ds_read_b64_tr_b16 a[216:217], v37 offset:49152
    ds_read_b64_tr_b16 a[218:219], v37 offset:50176
    ds_read_b64_tr_b16 a[220:221], v37 offset:57344
    ds_read_b64_tr_b16 a[222:223], v37 offset:58368
    s_waitcnt lgkmcnt(0)
    s_waitcnt vmcnt(25)
    s_barrier
    s_add_u32 s92, s99, 0x180000
    s_add_u32 s93, s98, 0xc000
    s_mov_b32 m0, s93
    s_nop 0
    buffer_load_dwordx4 v32, s[76:79], s92 offen lds
    s_add_u32 s92, s99, 0x188000
    s_add_u32 s93, s98, 0xc400
    s_mov_b32 m0, s93
    s_nop 0
    buffer_load_dwordx4 v32, s[76:79], s92 offen lds
    s_add_u32 s92, s99, 0x190000
    s_add_u32 s93, s98, 0xc800
    s_mov_b32 m0, s93
    s_nop 0
    buffer_load_dwordx4 v33, s[76:79], s92 offen lds
    s_add_u32 s92, s99, 0x198000
    s_add_u32 s93, s98, 0xcc00
    s_mov_b32 m0, s93
    s_nop 0
    buffer_load_dwordx4 v33, s[76:79], s92 offen lds
    ds_read_b64_tr_b16 a[160:161], v38 offset:0
    ds_read_b64_tr_b16 a[162:163], v38 offset:1024
    ds_read_b64_tr_b16 a[164:165], v38 offset:8192
    ds_read_b64_tr_b16 a[166:167], v38 offset:9216
    ds_read_b64_tr_b16 a[224:225], v39 offset:0
    ds_read_b64_tr_b16 a[226:227], v39 offset:1024
    ds_read_b64_tr_b16 a[228:229], v39 offset:8192
    ds_read_b64_tr_b16 a[230:231], v39 offset:9216
    s_waitcnt lgkmcnt(0)
    s_waitcnt vmcnt(25)
    s_barrier
    s_add_u32 s92, s99, 0x200000
    s_add_u32 s93, s98, 0x10000
    s_mov_b32 m0, s93
    s_nop 0
    buffer_load_dwordx4 v32, s[76:79], s92 offen lds
    s_add_u32 s92, s99, 0x208000
    s_add_u32 s93, s98, 0x10400
    s_mov_b32 m0, s93
    s_nop 0
    buffer_load_dwordx4 v32, s[76:79], s92 offen lds
    s_add_u32 s92, s99, 0x210000
    s_add_u32 s93, s98, 0x10800
    s_mov_b32 m0, s93
    s_nop 0
    buffer_load_dwordx4 v33, s[76:79], s92 offen lds
    s_add_u32 s92, s99, 0x218000
    s_add_u32 s93, s98, 0x10c00
    s_mov_b32 m0, s93
    s_nop 0
    buffer_load_dwordx4 v33, s[76:79], s92 offen lds
    ds_read_b64_tr_b16 a[168:169], v38 offset:16384
    ds_read_b64_tr_b16 a[170:171], v38 offset:17408
    ds_read_b64_tr_b16 a[172:173], v38 offset:24576
    ds_read_b64_tr_b16 a[174:175], v38 offset:25600
    ds_read_b64_tr_b16 a[232:233], v39 offset:16384
    ds_read_b64_tr_b16 a[234:235], v39 offset:17408
    ds_read_b64_tr_b16 a[236:237], v39 offset:24576
    ds_read_b64_tr_b16 a[238:239], v39 offset:25600
    s_waitcnt lgkmcnt(0)
    s_waitcnt vmcnt(24)
    s_barrier
    s_add_u32 s92, s99, 0x280000
    s_add_u32 s93, s98, 0x14000
    s_mov_b32 m0, s93
    s_nop 0
    buffer_load_dwordx4 v32, s[76:79], s92 offen lds
    s_add_u32 s92, s99, 0x288000
    s_add_u32 s93, s98, 0x14400
    s_mov_b32 m0, s93
    s_nop 0
    buffer_load_dwordx4 v32, s[76:79], s92 offen lds
    s_add_u32 s92, s99, 0x290000
    s_add_u32 s93, s98, 0x14800
    s_mov_b32 m0, s93
    s_nop 0
    buffer_load_dwordx4 v33, s[76:79], s92 offen lds
    s_add_u32 s92, s99, 0x298000
    s_add_u32 s93, s98, 0x14c00
    s_mov_b32 m0, s93
    s_nop 0
    buffer_load_dwordx4 v33, s[76:79], s92 offen lds
    ds_read_b64_tr_b16 a[176:177], v38 offset:32768
    ds_read_b64_tr_b16 a[178:179], v38 offset:33792
    ds_read_b64_tr_b16 a[180:181], v38 offset:40960
    ds_read_b64_tr_b16 a[182:183], v38 offset:41984
    ds_read_b64_tr_b16 a[240:241], v39 offset:32768
    ds_read_b64_tr_b16 a[242:243], v39 offset:33792
    ds_read_b64_tr_b16 a[244:245], v39 offset:40960
    ds_read_b64_tr_b16 a[246:247], v39 offset:41984
    s_waitcnt lgkmcnt(0)
    s_waitcnt vmcnt(24)
    s_barrier
    s_add_u32 s92, s99, 0x300000
    s_add_u32 s93, s98, 0x18000
    s_mov_b32 m0, s93
    s_nop 0
    buffer_load_dwordx4 v32, s[76:79], s92 offen lds
    s_add_u32 s92, s99, 0x308000
    s_add_u32 s93, s98, 0x18400
    s_mov_b32 m0, s93
    s_nop 0
    buffer_load_dwordx4 v32, s[76:79], s92 offen lds
    s_add_u32 s92, s99, 0x310000
    s_add_u32 s93, s98, 0x18800
    s_mov_b32 m0, s93
    s_nop 0
    buffer_load_dwordx4 v33, s[76:79], s92 offen lds
    s_add_u32 s92, s99, 0x318000
    s_add_u32 s93, s98, 0x18c00
    s_mov_b32 m0, s93
    s_nop 0
    buffer_load_dwordx4 v33, s[76:79], s92 offen lds
    ds_read_b64_tr_b16 a[184:185], v38 offset:49152
    ds_read_b64_tr_b16 a[186:187], v38 offset:50176
    ds_read_b64_tr_b16 a[188:189], v38 offset:57344
    ds_read_b64_tr_b16 a[190:191], v38 offset:58368
    ds_read_b64_tr_b16 a[248:249], v39 offset:49152
    ds_read_b64_tr_b16 a[250:251], v39 offset:50176
    ds_read_b64_tr_b16 a[252:253], v39 offset:57344
    ds_read_b64_tr_b16 a[254:255], v39 offset:58368
    s_waitcnt lgkmcnt(0)
    s_waitcnt vmcnt(24)
    s_barrier
    s_add_u32 s92, s99, 0x380000
    s_add_u32 s93, s98, 0x1c000
    s_mov_b32 m0, s93
    s_nop 0
    buffer_load_dwordx4 v32, s[76:79], s92 offen lds
    s_add_u32 s92, s99, 0x388000
    s_add_u32 s93, s98, 0x1c400
    s_mov_b32 m0, s93
    s_nop 0
    buffer_load_dwordx4 v32, s[76:79], s92 offen lds
    s_add_u32 s92, s99, 0x390000
    s_add_u32 s93, s98, 0x1c800
    s_mov_b32 m0, s93
    s_nop 0
    buffer_load_dwordx4 v33, s[76:79], s92 offen lds
    s_add_u32 s92, s99, 0x398000
    s_add_u32 s93, s98, 0x1cc00
    s_mov_b32 m0, s93
    s_nop 0
    buffer_load_dwordx4 v33, s[76:79], s92 offen lds
    ds_read_b64_tr_b16 v[128:129], v36 offset:0
    ds_read_b64_tr_b16 v[130:131], v36 offset:1024
    ds_read_b64_tr_b16 v[132:133], v36 offset:8192
    ds_read_b64_tr_b16 v[134:135], v36 offset:9216
    ds_read_b64_tr_b16 v[192:193], v37 offset:0
    ds_read_b64_tr_b16 v[194:195], v37 offset:1024
    ds_read_b64_tr_b16 v[196:197], v37 offset:8192
    ds_read_b64_tr_b16 v[198:199], v37 offset:9216
    s_waitcnt lgkmcnt(0)
    s_waitcnt vmcnt(24)
    s_barrier
    s_add_u32 s92, s100, 0x0
    s_add_u32 s93, s98, 0x0
    s_mov_b32 m0, s93
    s_nop 0
    buffer_load_dwordx4 v106, s[80:83], s92 offen lds
    s_add_u32 s92, s100, 0x1000
    s_add_u32 s93, s98, 0x400
    s_mov_b32 m0, s93
    s_nop 0
    buffer_load_dwordx4 v107, s[80:83], s92 offen lds
    s_add_u32 s92, s100, 0x2000
    s_add_u32 s93, s98, 0x800
    s_mov_b32 m0, s93
    s_nop 0
    buffer_load_dwordx4 v106, s[80:83], s92 offen lds
    s_add_u32 s92, s100, 0x3000
    s_add_u32 s93, s98, 0xc00
    s_mov_b32 m0, s93
    s_nop 0
    buffer_load_dwordx4 v107, s[80:83], s92 offen lds
    ds_read_b64_tr_b16 v[136:137], v36 offset:16384
    ds_read_b64_tr_b16 v[138:139], v36 offset:17408
    ds_read_b64_tr_b16 v[140:141], v36 offset:24576
    ds_read_b64_tr_b16 v[142:143], v36 offset:25600
    ds_read_b64_tr_b16 v[200:201], v37 offset:16384
    ds_read_b64_tr_b16 v[202:203], v37 offset:17408
    ds_read_b64_tr_b16 v[204:205], v37 offset:24576
    ds_read_b64_tr_b16 v[206:207], v37 offset:25600
    s_waitcnt lgkmcnt(0)
    s_waitcnt vmcnt(24)
    s_barrier
    s_add_u32 s92, s100, 0x10000
    s_add_u32 s93, s98, 0x4000
    s_mov_b32 m0, s93
    s_nop 0
    buffer_load_dwordx4 v106, s[80:83], s92 offen lds
    s_add_u32 s92, s100, 0x11000
    s_add_u32 s93, s98, 0x4400
    s_mov_b32 m0, s93
    s_nop 0
    buffer_load_dwordx4 v107, s[80:83], s92 offen lds
    s_add_u32 s92, s100, 0x12000
    s_add_u32 s93, s98, 0x4800
    s_mov_b32 m0, s93
    s_nop 0
    buffer_load_dwordx4 v106, s[80:83], s92 offen lds
    s_add_u32 s92, s100, 0x13000
    s_add_u32 s93, s98, 0x4c00
    s_mov_b32 m0, s93
    s_nop 0
    buffer_load_dwordx4 v107, s[80:83], s92 offen lds
    ds_read_b64_tr_b16 v[144:145], v36 offset:32768
    ds_read_b64_tr_b16 v[146:147], v36 offset:33792
    ds_read_b64_tr_b16 v[148:149], v36 offset:40960
    ds_read_b64_tr_b16 v[150:151], v36 offset:41984
    ds_read_b64_tr_b16 v[208:209], v37 offset:32768
    ds_read_b64_tr_b16 v[210:211], v37 offset:33792
    ds_read_b64_tr_b16 v[212:213], v37 offset:40960
    ds_read_b64_tr_b16 v[214:215], v37 offset:41984
    s_waitcnt lgkmcnt(0)
    s_waitcnt vmcnt(24)
    s_barrier
    s_add_u32 s92, s100, 0x100
    s_add_u32 s93, s98, 0x8000
    s_mov_b32 m0, s93
    s_nop 0
    buffer_load_dwordx4 v106, s[80:83], s92 offen lds
    s_add_u32 s92, s100, 0x1100
    s_add_u32 s93, s98, 0x8400
    s_mov_b32 m0, s93
    s_nop 0
    buffer_load_dwordx4 v107, s[80:83], s92 offen lds
    s_add_u32 s92, s100, 0x2100
    s_add_u32 s93, s98, 0x8800
    s_mov_b32 m0, s93
    s_nop 0
    buffer_load_dwordx4 v106, s[80:83], s92 offen lds
    s_add_u32 s92, s100, 0x3100
    s_add_u32 s93, s98, 0x8c00
    s_mov_b32 m0, s93
    s_nop 0
    buffer_load_dwordx4 v107, s[80:83], s92 offen lds
    ds_read_b64_tr_b16 v[152:153], v36 offset:49152
    ds_read_b64_tr_b16 v[154:155], v36 offset:50176
    ds_read_b64_tr_b16 v[156:157], v36 offset:57344
    ds_read_b64_tr_b16 v[158:159], v36 offset:58368
    ds_read_b64_tr_b16 v[216:217], v37 offset:49152
    ds_read_b64_tr_b16 v[218:219], v37 offset:50176
    ds_read_b64_tr_b16 v[220:221], v37 offset:57344
    ds_read_b64_tr_b16 v[222:223], v37 offset:58368
    s_waitcnt lgkmcnt(0)
    s_waitcnt vmcnt(24)
    s_barrier
    s_add_u32 s92, s100, 0x10100
    s_add_u32 s93, s98, 0xc000
    s_mov_b32 m0, s93
    s_nop 0
    buffer_load_dwordx4 v106, s[80:83], s92 offen lds
    s_add_u32 s92, s100, 0x11100
    s_add_u32 s93, s98, 0xc400
    s_mov_b32 m0, s93
    s_nop 0
    buffer_load_dwordx4 v107, s[80:83], s92 offen lds
    s_add_u32 s92, s100, 0x12100
    s_add_u32 s93, s98, 0xc800
    s_mov_b32 m0, s93
    s_nop 0
    buffer_load_dwordx4 v106, s[80:83], s92 offen lds
    s_add_u32 s92, s100, 0x13100
    s_add_u32 s93, s98, 0xcc00
    s_mov_b32 m0, s93
    s_nop 0
    buffer_load_dwordx4 v107, s[80:83], s92 offen lds
    ds_read_b64_tr_b16 v[160:161], v38 offset:0
    ds_read_b64_tr_b16 v[162:163], v38 offset:1024
    ds_read_b64_tr_b16 v[164:165], v38 offset:8192
    ds_read_b64_tr_b16 v[166:167], v38 offset:9216
    ds_read_b64_tr_b16 v[224:225], v39 offset:0
    ds_read_b64_tr_b16 v[226:227], v39 offset:1024
    ds_read_b64_tr_b16 v[228:229], v39 offset:8192
    ds_read_b64_tr_b16 v[230:231], v39 offset:9216
    s_waitcnt lgkmcnt(0)
    s_waitcnt vmcnt(24)
    s_barrier
    s_add_u32 s92, s100, 0x200
    s_add_u32 s93, s98, 0x10000
    s_mov_b32 m0, s93
    s_nop 0
    buffer_load_dwordx4 v106, s[80:83], s92 offen lds
    s_add_u32 s92, s100, 0x1200
    s_add_u32 s93, s98, 0x10400
    s_mov_b32 m0, s93
    s_nop 0
    buffer_load_dwordx4 v107, s[80:83], s92 offen lds
    s_add_u32 s92, s100, 0x2200
    s_add_u32 s93, s98, 0x10800
    s_mov_b32 m0, s93
    s_nop 0
    buffer_load_dwordx4 v106, s[80:83], s92 offen lds
    s_add_u32 s92, s100, 0x3200
    s_add_u32 s93, s98, 0x10c00
    s_mov_b32 m0, s93
    s_nop 0
    buffer_load_dwordx4 v107, s[80:83], s92 offen lds
    ds_read_b64_tr_b16 v[168:169], v38 offset:16384
    ds_read_b64_tr_b16 v[170:171], v38 offset:17408
    ds_read_b64_tr_b16 v[172:173], v38 offset:24576
    ds_read_b64_tr_b16 v[174:175], v38 offset:25600
    ds_read_b64_tr_b16 v[232:233], v39 offset:16384
    ds_read_b64_tr_b16 v[234:235], v39 offset:17408
    ds_read_b64_tr_b16 v[236:237], v39 offset:24576
    ds_read_b64_tr_b16 v[238:239], v39 offset:25600
    s_waitcnt lgkmcnt(0)
    s_waitcnt vmcnt(24)
    s_barrier
    s_add_u32 s92, s100, 0x10200
    s_add_u32 s93, s98, 0x14000
    s_mov_b32 m0, s93
    s_nop 0
    buffer_load_dwordx4 v106, s[80:83], s92 offen lds
    s_add_u32 s92, s100, 0x11200
    s_add_u32 s93, s98, 0x14400
    s_mov_b32 m0, s93
    s_nop 0
    buffer_load_dwordx4 v107, s[80:83], s92 offen lds
    s_add_u32 s92, s100, 0x12200
    s_add_u32 s93, s98, 0x14800
    s_mov_b32 m0, s93
    s_nop 0
    buffer_load_dwordx4 v106, s[80:83], s92 offen lds
    s_add_u32 s92, s100, 0x13200
    s_add_u32 s93, s98, 0x14c00
    s_mov_b32 m0, s93
    s_nop 0
    buffer_load_dwordx4 v107, s[80:83], s92 offen lds
    ds_read_b64_tr_b16 v[176:177], v38 offset:32768
    ds_read_b64_tr_b16 v[178:179], v38 offset:33792
    ds_read_b64_tr_b16 v[180:181], v38 offset:40960
    ds_read_b64_tr_b16 v[182:183], v38 offset:41984
    ds_read_b64_tr_b16 v[240:241], v39 offset:32768
    ds_read_b64_tr_b16 v[242:243], v39 offset:33792
    ds_read_b64_tr_b16 v[244:245], v39 offset:40960
    ds_read_b64_tr_b16 v[246:247], v39 offset:41984
    s_waitcnt lgkmcnt(0)
    s_waitcnt vmcnt(24)
    s_barrier
    s_add_u32 s92, s100, 0x300
    s_add_u32 s93, s98, 0x18000
    s_mov_b32 m0, s93
    s_nop 0
    buffer_load_dwordx4 v106, s[80:83], s92 offen lds
    s_add_u32 s92, s100, 0x1300
    s_add_u32 s93, s98, 0x18400
    s_mov_b32 m0, s93
    s_nop 0
    buffer_load_dwordx4 v107, s[80:83], s92 offen lds
    s_add_u32 s92, s100, 0x2300
    s_add_u32 s93, s98, 0x18800
    s_mov_b32 m0, s93
    s_nop 0
    buffer_load_dwordx4 v106, s[80:83], s92 offen lds
    s_add_u32 s92, s100, 0x3300
    s_add_u32 s93, s98, 0x18c00
    s_mov_b32 m0, s93
    s_nop 0
    buffer_load_dwordx4 v107, s[80:83], s92 offen lds
    ds_read_b64_tr_b16 v[184:185], v38 offset:49152
    ds_read_b64_tr_b16 v[186:187], v38 offset:50176
    ds_read_b64_tr_b16 v[188:189], v38 offset:57344
    ds_read_b64_tr_b16 v[190:191], v38 offset:58368
    ds_read_b64_tr_b16 v[248:249], v39 offset:49152
    ds_read_b64_tr_b16 v[250:251], v39 offset:50176
    ds_read_b64_tr_b16 v[252:253], v39 offset:57344
    ds_read_b64_tr_b16 v[254:255], v39 offset:58368
    s_waitcnt lgkmcnt(0)
    s_waitcnt vmcnt(24)
    s_barrier
    s_add_u32 s92, s100, 0x10300
    s_add_u32 s93, s98, 0x1c000
    s_mov_b32 m0, s93
    s_nop 0
    buffer_load_dwordx4 v106, s[80:83], s92 offen lds
    s_add_u32 s92, s100, 0x11300
    s_add_u32 s93, s98, 0x1c400
    s_mov_b32 m0, s93
    s_nop 0
    buffer_load_dwordx4 v107, s[80:83], s92 offen lds
    s_add_u32 s92, s100, 0x12300
    s_add_u32 s93, s98, 0x1c800
    s_mov_b32 m0, s93
    s_nop 0
    buffer_load_dwordx4 v106, s[80:83], s92 offen lds
    s_add_u32 s92, s100, 0x13300
    s_add_u32 s93, s98, 0x1cc00
    s_mov_b32 m0, s93
    s_nop 0
    buffer_load_dwordx4 v107, s[80:83], s92 offen lds
    ds_read_b64_tr_b16 v[64:65], v108 offset:0
    ds_read_b64_tr_b16 v[66:67], v108 offset:512
    ds_read_b64_tr_b16 v[68:69], v108 offset:8192
    ds_read_b64_tr_b16 v[70:71], v108 offset:8704
    ds_read_b64_tr_b16 v[72:73], v109 offset:0
    ds_read_b64_tr_b16 v[74:75], v109 offset:512
    ds_read_b64_tr_b16 v[76:77], v109 offset:8192
    ds_read_b64_tr_b16 v[78:79], v109 offset:8704
    s_waitcnt lgkmcnt(0)
    s_waitcnt vmcnt(24)
    s_barrier
    ds_write_b128 v112, v[64:67] offset:0
    ds_write_b128 v112, v[68:71] offset:1024
    ds_write_b128 v112, v[72:75] offset:8192
    ds_write_b128 v112, v[76:79] offset:9216
    ds_read_b64_tr_b16 v[80:81], v108 offset:16384
    ds_read_b64_tr_b16 v[82:83], v108 offset:16896
    ds_read_b64_tr_b16 v[84:85], v108 offset:24576
    ds_read_b64_tr_b16 v[86:87], v108 offset:25088
    ds_read_b64_tr_b16 v[88:89], v109 offset:16384
    ds_read_b64_tr_b16 v[90:91], v109 offset:16896
    ds_read_b64_tr_b16 v[92:93], v109 offset:24576
    ds_read_b64_tr_b16 v[94:95], v109 offset:25088
    s_waitcnt lgkmcnt(0)
    s_waitcnt vmcnt(20)
    s_barrier
    ds_write_b128 v112, v[80:83] offset:16384
    ds_write_b128 v112, v[84:87] offset:17408
    ds_write_b128 v112, v[88:91] offset:24576
    ds_write_b128 v112, v[92:95] offset:25600
    ds_read_b64_tr_b16 v[64:65], v108 offset:32768
    ds_read_b64_tr_b16 v[66:67], v108 offset:33280
    ds_read_b64_tr_b16 v[68:69], v108 offset:40960
    ds_read_b64_tr_b16 v[70:71], v108 offset:41472
    ds_read_b64_tr_b16 v[72:73], v109 offset:32768
    ds_read_b64_tr_b16 v[74:75], v109 offset:33280
    ds_read_b64_tr_b16 v[76:77], v109 offset:40960
    ds_read_b64_tr_b16 v[78:79], v109 offset:41472
    s_waitcnt lgkmcnt(0)
    s_waitcnt vmcnt(16)
    s_barrier
    ds_write_b128 v112, v[64:67] offset:32768
    ds_write_b128 v112, v[68:71] offset:33792
    ds_write_b128 v112, v[72:75] offset:40960
    ds_write_b128 v112, v[76:79] offset:41984
    ds_read_b64_tr_b16 v[80:81], v108 offset:49152
    ds_read_b64_tr_b16 v[82:83], v108 offset:49664
    ds_read_b64_tr_b16 v[84:85], v108 offset:57344
    ds_read_b64_tr_b16 v[86:87], v108 offset:57856
    ds_read_b64_tr_b16 v[88:89], v109 offset:49152
    ds_read_b64_tr_b16 v[90:91], v109 offset:49664
    ds_read_b64_tr_b16 v[92:93], v109 offset:57344
    ds_read_b64_tr_b16 v[94:95], v109 offset:57856
    s_waitcnt lgkmcnt(0)
    s_lshl_b32 s81, s64, 11
    s_lshl_b32 s51, s64, 12
    s_and_b32 s4, s64, 1
    s_lshl_b32 s4, s4, 11
    s_add_u32 s51, s51, s4
    s_xor_b32 s42, s51, 0x800
    s_sub_u32 s42, s42, 1024
    s_add_u32 s44, s51, 0x8190000
    s_add_u32 s45, s42, 0x8190000
    s_add_u32 s69, s81, 0x24000
    s_mov_b32 s70, 0
    s_mov_b32 s71, 18432
    s_mov_b32 s72, 36864
    s_mov_b32 s62, 55296
    s_mul_i32 s63, s31, 3
    s_sub_i32 s63, s63, 4
    s_max_i32 s63, s63, 0
    s_lshl_b32 s4, s65, 13
    s_add_u32 s74, s4, s81
    s_add_u32 s73, s74, 0x1000000
    s_add_u32 s75, s81, 0x20000
    s_mov_b32 s80, 0
    s_lshl_b32 s76, s65, 2
    s_add_u32 s76, s76, 0x81a0000
    s_mov_b32 s77, 0x8000000
    s_mov_b32 s78, 0x819c000
    s_mov_b32 s79, 0x3e0293ee
    s_mov_b32 s58, s79
    s_mov_b32 s59, s79
    s_cmp_le_u32 s64, 0
    s_cselect_b64 s[32:33], -1, 0
    s_cmp_le_u32 s64, 1
    s_cselect_b64 s[34:35], -1, 0
    s_cmp_le_u32 s64, 2
    s_cselect_b64 s[36:37], -1, 0
    s_mov_b32 s50, 0
    s_mov_b32 s60, 0xff00ff00
    s_mov_b32 s61, 0xff00ff00
    v_add_u32 v50, s69, v1
    ds_write2st64_b32 v50, v12, v12 offset0:0 offset1:4
    v_lshlrev_b32 v61, 2, v3
L_gate_1:
    buffer_load_dword v60, v61, s[24:27], 0 offen sc1
    s_waitcnt vmcnt(0)
    v_readlane_b32 s93, v60, 2
    v_readlane_b32 s94, v60, 18
    s_nop 0
    s_add_u32 s93, s93, s94
    v_readlane_b32 s94, v60, 34
    s_nop 0
    s_add_u32 s93, s93, s94
    v_readlane_b32 s94, v60, 50
    s_nop 0
    s_add_u32 s93, s93, s94
    v_readlane_b32 s94, v60, 3
    s_nop 0
    s_add_u32 s93, s93, s94
    v_readlane_b32 s94, v60, 19
    s_nop 0
    s_add_u32 s93, s93, s94
    v_readlane_b32 s94, v60, 35
    s_nop 0
    s_add_u32 s93, s93, s94
    v_readlane_b32 s94, v60, 51
    s_nop 0
    s_add_u32 s93, s93, s94
    v_readlane_b32 s92, v60, 0
    s_cmp_eq_u32 s93, 256
    s_cbranch_scc1 L_gate_1_ok
    s_sleep 2
    s_sub_u32 s28, s28, 1
    s_cbranch_scc1 L_fail
    s_branch L_gate_1
L_gate_1_ok:
    v_min_u32 v27, -2, v27
    s_mov_b32 s30, s92
    s_mov_b32 s4, 0x8190000
    buffer_store_dword v27, v16, s[8:11], s4 offen sc1
    v_and_b32 v51, 3, v3
    v_cmp_eq_u32 vcc, 0, v51
    s_nop 1
    v_cndmask_b32 v0, 0, 1, vcc
    v_mov_b32 v3, v50
L_c_flag0:
    buffer_load_dword v26, v121, s[8:11], s76 offen sc1
    s_waitcnt vmcnt(0)
    v_cmp_eq_u32 vcc, -1, v26
    s_cbranch_vccz L_c_flag0_ok
    s_sleep 2
    s_sub_u32 s28, s28, 1
    s_cbranch_scc1 L_fail
    s_branch L_c_flag0
L_c_flag0_ok:
    s_mov_b32 m0, s75
    s_nop 0
    buffer_load_dwordx4 v1, s[8:11], s74 offen sc1 lds
    s_mov_b32 m0, s75
    s_nop 0
    buffer_load_dwordx4 v1, s[8:11], s74 offen offset:1024 sc1 lds
    buffer_load_dword v26, v121, s[8:11], s76 offen offset:128 sc1
    s_add_u32 s74, s74, 0x40000
    s_xor_b32 s75, s75, 0x2000
    s_mov_b32 s29, 0
    s_waitcnt vmcnt(15)
    s_barrier
    ds_write_b128 v112, v[80:83] offset:49152
    ds_write_b128 v112, v[84:87] offset:50176
    ds_write_b128 v112, v[88:91] offset:57344
    ds_write_b128 v112, v[92:95] offset:58368
    ds_read_b64_tr_b16 v[64:65], v110 offset:0
    ds_read_b64_tr_b16 v[66:67], v110 offset:512
    ds_read_b64_tr_b16 v[68:69], v110 offset:8192
    ds_read_b64_tr_b16 v[70:71], v110 offset:8704
    ds_read_b64_tr_b16 v[72:73], v111 offset:0
    ds_read_b64_tr_b16 v[74:75], v111 offset:512
    ds_read_b64_tr_b16 v[76:77], v111 offset:8192
    ds_read_b64_tr_b16 v[78:79], v111 offset:8704
    s_waitcnt lgkmcnt(0)
    s_waitcnt vmcnt(11)
    s_barrier
    ds_write_b128 v113, v[64:67] offset:0
    ds_write_b128 v113, v[68:71] offset:1024
    ds_write_b128 v113, v[72:75] offset:8192
    ds_write_b128 v113, v[76:79] offset:9216
    ds_read_b64_tr_b16 v[80:81], v110 offset:16384
    ds_read_b64_tr_b16 v[82:83], v110 offset:16896
    ds_read_b64_tr_b16 v[84:85], v110 offset:24576
    ds_read_b64_tr_b16 v[86:87], v110 offset:25088
    ds_read_b64_tr_b16 v[88:89], v111 offset:16384
    ds_read_b64_tr_b16 v[90:91], v111 offset:16896
    ds_read_b64_tr_b16 v[92:93], v111 offset:24576
    ds_read_b64_tr_b16 v[94:95], v111 offset:25088
    s_waitcnt lgkmcnt(0)
    s_waitcnt vmcnt(7)
    s_barrier
    ds_write_b128 v113, v[80:83] offset:16384
    ds_write_b128 v113, v[84:87] offset:17408
    ds_write_b128 v113, v[88:91] offset:24576
    ds_write_b128 v113, v[92:95] offset:25600
    ds_read_b64_tr_b16 v[64:65], v110 offset:32768
    ds_read_b64_tr_b16 v[66:67], v110 offset:33280
    ds_read_b64_tr_b16 v[68:69], v110 offset:40960
    ds_read_b64_tr_b16 v[70:71], v110 offset:41472
    ds_read_b64_tr_b16 v[72:73], v111 offset:32768
    ds_read_b64_tr_b16 v[74:75], v111 offset:33280
    ds_read_b64_tr_b16 v[76:77], v111 offset:40960
    ds_read_b64_tr_b16 v[78:79], v111 offset:41472
    s_waitcnt lgkmcnt(0)
    s_waitcnt vmcnt(3)
    s_barrier
    ds_write_b128 v113, v[64:67] offset:32768
    ds_write_b128 v113, v[68:71] offset:33792
    ds_write_b128 v113, v[72:75] offset:40960
    ds_write_b128 v113, v[76:79] offset:41984
    ds_read_b64_tr_b16 v[80:81], v110 offset:49152
    ds_read_b64_tr_b16 v[82:83], v110 offset:49664
    ds_read_b64_tr_b16 v[84:85], v110 offset:57344
    ds_read_b64_tr_b16 v[86:87], v110 offset:57856
    ds_read_b64_tr_b16 v[88:89], v111 offset:49152
    ds_read_b64_tr_b16 v[90:91], v111 offset:49664
    ds_read_b64_tr_b16 v[92:93], v111 offset:57344
    ds_read_b64_tr_b16 v[94:95], v111 offset:57856
    s_waitcnt lgkmcnt(0)
    s_barrier
    ds_write_b128 v113, v[80:83] offset:49152
    ds_write_b128 v113, v[84:87] offset:50176
    ds_write_b128 v113, v[88:91] offset:57344
    ds_write_b128 v113, v[92:95] offset:58368
    s_waitcnt lgkmcnt(0)
    v_mov_b64 v[80:81], 0
    v_mov_b64 v[82:83], 0
    v_mov_b64 v[84:85], 0
    v_mov_b64 v[86:87], 0
    v_mov_b64 v[92:93], 0
    v_mov_b64 v[94:95], 0
    v_mov_b64 v[96:97], 0
    v_mov_b64 v[98:99], 0
    v_mov_b64 v[100:101], 0
    v_mov_b64 v[102:103], 0
    v_mov_b64 v[104:105], 0
    v_mov_b64 v[106:107], 0
    s_waitcnt vmcnt(0) lgkmcnt(0)
    s_cmp_ge_u32 s30, 32
    s_cbranch_scc0 L_chain_far
    s_mov_b32 m0, s69
    s_nop 0
    buffer_load_dwordx4 v25, s[8:11], s44 offen sc1 lds
    buffer_load_dwordx4 v25, s[8:11], s45 offen offset:1024 sc1 lds
    s_mov_b64 s[46:47], -1
    s_mov_b64 s[48:49], -1
    s_barrier
L_step_n0:
    ds_read_b128 v[32:35], v21 offset:16384
    ds_read_b128 v[36:39], v21 offset:18432
    ds_read_b128 v[48:51], v21 offset:16384
    ds_read_b128 v[52:55], v21 offset:18432
    s_waitcnt lgkmcnt(2)
    v_max_u32 v28, v32, v36
    v_cmp_eq_u32 vcc, -1, v28
    s_cbranch_vccz L_got_n0
    ds_read_b128 v[32:35], v21 offset:16384
    ds_read_b128 v[36:39], v21 offset:18432
    s_waitcnt lgkmcnt(2)
    v_max_u32 v28, v48, v52
    v_cmp_eq_u32 vcc, -1, v28
    s_cbranch_vccz L_gotb_n0
    ds_read_b128 v[48:51], v21 offset:16384
    ds_read_b128 v[52:55], v21 offset:18432
    s_waitcnt lgkmcnt(2)
    v_max_u32 v28, v32, v36
    v_cmp_eq_u32 vcc, -1, v28
    s_cbranch_vccz L_got_n0
    ds_read_b128 v[32:35], v21 offset:16384
    ds_read_b128 v[36:39], v21 offset:18432
    ds_read2st64_b32 v[30:31], v3 offset0:0 offset1:4
    s_waitcnt lgkmcnt(3)
    v_max_u32 v28, v48, v52
    v_cmp_eq_u32 vcc, -1, v28
    s_cbranch_vccz L_gotb_n0
    ds_read_b128 v[48:51], v21 offset:16384
    ds_read_b128 v[52:55], v21 offset:18432
    s_waitcnt lgkmcnt(2)
    v_max_u32 v28, v32, v36
    v_cmp_eq_u32 vcc, -1, v28
    v_cmp_eq_u32 s[46:47], -1, v30
    v_cmp_eq_u32 s[48:49], -1, v31
    s_cbranch_vccz L_got_n0
    ds_read_b128 v[32:35], v21 offset:16384
    ds_read_b128 v[36:39], v21 offset:18432
    s_and_b64 exec, s[46:47], s[34:35]
    buffer_load_dwordx4 v25, s[8:11], s44 offen sc1 lds
    s_and_b64 exec, s[48:49], s[34:35]
    buffer_load_dwordx4 v25, s[8:11], s45 offen offset:1024 sc1 lds
    s_mov_b64 exec, -1
    s_waitcnt lgkmcnt(2)
    v_max_u32 v28, v48, v52
    v_cmp_eq_u32 vcc, -1, v28
    s_cbranch_vccz L_gotb_n0
    ds_read_b128 v[48:51], v21 offset:16384
    ds_read_b128 v[52:55], v21 offset:18432
    ds_read2st64_b32 v[30:31], v3 offset0:0 offset1:4
    s_waitcnt lgkmcnt(3)
    v_max_u32 v28, v32, v36
    v_cmp_eq_u32 vcc, -1, v28
    s_cbranch_vccz L_got_n0
    ds_read_b128 v[32:35], v21 offset:16384
    ds_read_b128 v[36:39], v21 offset:18432
    s_waitcnt lgkmcnt(2)
    v_max_u32 v28, v48, v52
    v_cmp_eq_u32 vcc, -1, v28
    v_cmp_eq_u32 s[46:47], -1, v30
    v_cmp_eq_u32 s[48:49], -1, v31
    s_cbranch_vccz L_gotb_n0
    ds_read_b128 v[48:51], v21 offset:16384
    ds_read_b128 v[52:55], v21 offset:18432
    s_and_b64 exec, s[46:47], s[34:35]
    buffer_load_dwordx4 v25, s[8:11], s44 offen sc1 lds
    s_and_b64 exec, s[48:49], s[34:35]
    buffer_load_dwordx4 v25, s[8:11], s45 offen offset:1024 sc1 lds
    s_mov_b64 exec, -1
    s_waitcnt lgkmcnt(2)
    v_max_u32 v28, v32, v36
    v_cmp_eq_u32 vcc, -1, v28
    s_cbranch_vccz L_got_n0
    ds_read_b128 v[32:35], v21 offset:16384
    ds_read_b128 v[36:39], v21 offset:18432
    ds_read2st64_b32 v[30:31], v3 offset0:0 offset1:4
    s_waitcnt lgkmcnt(3)
    v_max_u32 v28, v48, v52
    v_cmp_eq_u32 vcc, -1, v28
    s_cbranch_vccz L_gotb_n0
    ds_read_b128 v[48:51], v21 offset:16384
    ds_read_b128 v[52:55], v21 offset:18432
    s_waitcnt lgkmcnt(2)
    v_max_u32 v28, v32, v36
    v_cmp_eq_u32 vcc, -1, v28
    v_cmp_eq_u32 s[46:47], -1, v30
    v_cmp_eq_u32 s[48:49], -1, v31
    s_cbranch_vccz L_got_n0
    ds_read_b128 v[32:35], v21 offset:16384
    ds_read_b128 v[36:39], v21 offset:18432
    s_and_b64 exec, s[46:47], s[34:35]
    buffer_load_dwordx4 v25, s[8:11], s44 offen sc1 lds
    s_and_b64 exec, s[48:49], s[34:35]
    buffer_load_dwordx4 v25, s[8:11], s45 offen offset:1024 sc1 lds
    s_mov_b64 exec, -1
    s_waitcnt lgkmcnt(2)
    v_max_u32 v28, v48, v52
    v_cmp_eq_u32 vcc, -1, v28
    s_cbranch_vccz L_gotb_n0
    ds_read_b128 v[48:51], v21 offset:16384
    ds_read_b128 v[52:55], v21 offset:18432
    ds_read2st64_b32 v[30:31], v3 offset0:0 offset1:4
    s_waitcnt lgkmcnt(3)
    v_max_u32 v28, v32, v36
    v_cmp_eq_u32 vcc, -1, v28
    s_cbranch_vccz L_got_n0
    ds_read_b128 v[32:35], v21 offset:16384
    ds_read_b128 v[36:39], v21 offset:18432
    s_waitcnt lgkmcnt(2)
    v_max_u32 v28, v48, v52
    v_cmp_eq_u32 vcc, -1, v28
    v_cmp_eq_u32 s[46:47], -1, v30
    v_cmp_eq_u32 s[48:49], -1, v31
    s_cbranch_vccz L_gotb_n0
    ds_read_b128 v[48:51], v21 offset:16384
    ds_read_b128 v[52:55], v21 offset:18432
    s_and_b64 exec, s[46:47], s[34:35]
    buffer_load_dwordx4 v25, s[8:11], s44 offen sc1 lds
    s_and_b64 exec, s[48:49], s[34:35]
    buffer_load_dwordx4 v25, s[8:11], s45 offen offset:1024 sc1 lds
    s_mov_b64 exec, -1
    s_waitcnt lgkmcnt(2)
    v_max_u32 v28, v32, v36
    v_cmp_eq_u32 vcc, -1, v28
    s_cbranch_vccz L_got_n0
    ds_read_b128 v[32:35], v21 offset:16384
    ds_read_b128 v[36:39], v21 offset:18432
    ds_read2st64_b32 v[30:31], v3 offset0:0 offset1:4
    s_waitcnt lgkmcnt(3)
    v_max_u32 v28, v48, v52
    v_cmp_eq_u32 vcc, -1, v28
    s_cbranch_vccz L_gotb_n0
    ds_read_b128 v[48:51], v21 offset:16384
    ds_read_b128 v[52:55], v21 offset:18432
    s_waitcnt lgkmcnt(2)
    v_max_u32 v28, v32, v36
    v_cmp_eq_u32 vcc, -1, v28
    v_cmp_eq_u32 s[46:47], -1, v30
    v_cmp_eq_u32 s[48:49], -1, v31
    s_cbranch_vccz L_got_n0
    ds_read_b128 v[32:35], v21 offset:16384
    ds_read_b128 v[36:39], v21 offset:18432
    s_and_b64 exec, s[46:47], s[34:35]
    buffer_load_dwordx4 v25, s[8:11], s44 offen sc1 lds
    s_and_b64 exec, s[48:49], s[34:35]
    buffer_load_dwordx4 v25, s[8:11], s45 offen offset:1024 sc1 lds
    s_mov_b64 exec, -1
    s_waitcnt lgkmcnt(2)
    v_max_u32 v28, v48, v52
    v_cmp_eq_u32 vcc, -1, v28
    s_cbranch_vccz L_gotb_n0
    ds_read_b128 v[48:51], v21 offset:16384
    ds_read_b128 v[52:55], v21 offset:18432
    ds_read2st64_b32 v[30:31], v3 offset0:0 offset1:4
    s_waitcnt lgkmcnt(3)
    v_max_u32 v28, v32, v36
    v_cmp_eq_u32 vcc, -1, v28
    s_cbranch_vccz L_got_n0
    ds_read_b128 v[32:35], v21 offset:16384
    ds_read_b128 v[36:39], v21 offset:18432
    s_waitcnt lgkmcnt(2)
    v_max_u32 v28, v48, v52
    v_cmp_eq_u32 vcc, -1, v28
    v_cmp_eq_u32 s[46:47], -1, v30
    v_cmp_eq_u32 s[48:49], -1, v31
    s_cbranch_vccz L_gotb_n0
L_spin_n0:
    s_sub_u32 s28, s28, 1
    s_cbranch_scc1 L_fail
    ds_read_b128 v[48:51], v21 offset:16384
    ds_read_b128 v[52:55], v21 offset:18432
    s_mov_b64 exec, s[46:47]
    buffer_load_dwordx4 v25, s[8:11], s44 offen sc1 lds
    s_mov_b64 exec, s[48:49]
    buffer_load_dwordx4 v25, s[8:11], s45 offen offset:1024 sc1 lds
    s_mov_b64 exec, -1
    s_waitcnt lgkmcnt(2)
    v_max_u32 v28, v32, v36
    v_cmp_eq_u32 vcc, -1, v28
    s_cbranch_vccz L_got_n0
    ds_read_b128 v[32:35], v21 offset:16384
    ds_read_b128 v[36:39], v21 offset:18432
    s_waitcnt lgkmcnt(2)
    v_max_u32 v28, v48, v52
    v_cmp_eq_u32 vcc, -1, v28
    s_cbranch_vccz L_gotb_n0
    ds_read_b128 v[48:51], v21 offset:16384
    ds_read_b128 v[52:55], v21 offset:18432
    ds_read2st64_b32 v[30:31], v3 offset0:0 offset1:4
    s_waitcnt lgkmcnt(3)
    v_max_u32 v28, v32, v36
    v_cmp_eq_u32 vcc, -1, v28
    s_cbranch_vccz L_got_n0
    ds_read_b128 v[32:35], v21 offset:16384
    ds_read_b128 v[36:39], v21 offset:18432
    s_waitcnt lgkmcnt(2)
    v_max_u32 v28, v48, v52
    v_cmp_eq_u32 vcc, -1, v28
    v_cmp_eq_u32 s[46:47], -1, v30
    v_cmp_eq_u32 s[48:49], -1, v31
    s_cbranch_vccnz L_spin_n0
L_gotb_n0:
    s_waitcnt lgkmcnt(0)
L_got_n0:
L_go0_n0:
    v_smfmac_f32_16x16x64_bf16 v[80:83], v[32:35], a[0:7], v2
    s_mov_b64 exec, s[46:47]
    buffer_load_dwordx4 v25, s[8:11], s44 offen sc1 lds
    s_mov_b64 exec, s[48:49]
    buffer_load_dwordx4 v25, s[8:11], s45 offen offset:1024 sc1 lds
    s_mov_b64 exec, -1
    v_smfmac_f32_16x16x64_bf16 v[84:87], v[32:35], a[64:71], v2
    v_smfmac_f32_16x16x64_bf16 v[92:95], v[32:35], a[128:135], v2
    v_smfmac_f32_16x16x64_bf16 v[96:99], v[32:35], a[192:199], v2
    v_smfmac_f32_16x16x64_bf16 v[100:103], v[32:35], v[128:135], v2
    v_smfmac_f32_16x16x64_bf16 v[104:107], v[32:35], v[192:199], v2
    ds_read_b128 v[40:43], v21 offset:17408
L_go1_n0:
    v_smfmac_f32_16x16x64_bf16 v[80:83], v[36:39], a[8:15], v2
    s_mov_b64 exec, s[46:47]
    buffer_load_dwordx4 v25, s[8:11], s44 offen sc1 lds
    s_mov_b64 exec, s[48:49]
    buffer_load_dwordx4 v25, s[8:11], s45 offen offset:1024 sc1 lds
    s_mov_b64 exec, -1
    v_smfmac_f32_16x16x64_bf16 v[84:87], v[36:39], a[72:79], v2
    v_smfmac_f32_16x16x64_bf16 v[92:95], v[36:39], a[136:143], v2
    v_smfmac_f32_16x16x64_bf16 v[96:99], v[36:39], a[200:207], v2
    s_waitcnt lgkmcnt(0)
    v_cmp_eq_u32 vcc, -1, v40
    v_smfmac_f32_16x16x64_bf16 v[100:103], v[36:39], v[136:143], v2
    v_smfmac_f32_16x16x64_bf16 v[104:107], v[36:39], v[200:207], v2
    ds_read_b128 v[44:47], v21 offset:19456
    s_cbranch_vccnz L_rty2_n0
L_go2_n0:
    v_smfmac_f32_16x16x64_bf16 v[80:83], v[40:43], a[16:23], v2
    v_smfmac_f32_16x16x64_bf16 v[84:87], v[40:43], a[80:87], v2
    v_smfmac_f32_16x16x64_bf16 v[92:95], v[40:43], a[144:151], v2
    v_smfmac_f32_16x16x64_bf16 v[96:99], v[40:43], a[208:215], v2
    s_waitcnt lgkmcnt(0)
    v_cmp_eq_u32 vcc, -1, v44
    v_smfmac_f32_16x16x64_bf16 v[100:103], v[40:43], v[144:151], v2
    v_smfmac_f32_16x16x64_bf16 v[104:107], v[40:43], v[208:215], v2
    ds_read_b128 v[32:35], v21 offset:20480
    s_cbranch_vccnz L_rty3_n0
L_go3_n0:
    v_smfmac_f32_16x16x64_bf16 v[80:83], v[44:47], a[24:31], v2
    v_smfmac_f32_16x16x64_bf16 v[84:87], v[44:47], a[88:95], v2
    v_smfmac_f32_16x16x64_bf16 v[92:95], v[44:47], a[152:159], v2
    v_smfmac_f32_16x16x64_bf16 v[96:99], v[44:47], a[216:223], v2
    s_waitcnt lgkmcnt(0)
    v_cmp_eq_u32 vcc, -1, v32
    v_smfmac_f32_16x16x64_bf16 v[100:103], v[44:47], v[152:159], v2
    ds_read_b128 v[36:39], v21 offset:22528
    v_smfmac_f32_16x16x64_bf16 v[104:107], v[44:47], v[216:223], v2
    s_cbranch_vccnz L_rty4_n0
L_go4_n0:
    v_smfmac_f32_16x16x64_bf16 v[80:83], v[32:35], a[32:39], v2
    ds_read_b128 v[40:43], v21 offset:21504
    v_smfmac_f32_16x16x64_bf16 v[84:87], v[32:35], a[96:103], v2
    s_waitcnt lgkmcnt(1)
    v_cmp_eq_u32 vcc, -1, v36
    v_smfmac_f32_16x16x64_bf16 v[92:95], v[32:35], a[160:167], v2
    v_smfmac_f32_16x16x64_bf16 v[96:99], v[32:35], a[224:231], v2
    buffer_store_dword v12, v16, s[8:11], s78 offen
    s_cbranch_vccnz L_rty5_n0
L_go5_n0:
    v_smfmac_f32_16x16x64_bf16 v[80:83], v[36:39], a[40:47], v2
    ds_read_b128 v[44:47], v21 offset:23552
    v_smfmac_f32_16x16x64_bf16 v[84:87], v[36:39], a[104:111], v2
    s_waitcnt lgkmcnt(1)
    v_cmp_eq_u32 vcc, -1, v40
    v_smfmac_f32_16x16x64_bf16 v[92:95], v[36:39], a[168:175], v2
    v_smfmac_f32_16x16x64_bf16 v[96:99], v[36:39], a[232:239], v2
    s_cbranch_vccnz L_rty6_n0
L_go6_n0:
    v_smfmac_f32_16x16x64_bf16 v[80:83], v[40:43], a[48:55], v2
    s_waitcnt lgkmcnt(0)
    v_cmp_eq_u32 vcc, -1, v44
    v_smfmac_f32_16x16x64_bf16 v[84:87], v[40:43], a[112:119], v2
    v_smfmac_f32_16x16x64_bf16 v[92:95], v[40:43], a[176:183], v2
    v_add_u32 v30, s80, v21
    s_cbranch_vccnz L_rty7_n0
L_go7_n0:
    v_smfmac_f32_16x16x64_bf16 v[80:83], v[44:47], a[56:63], v2
    buffer_load_dwordx4 v[108:111], v1, s[8:11], s73 offen sc1
    v_cmp_eq_u32 vcc, -1, v26
    v_smfmac_f32_16x16x64_bf16 v[84:87], v[44:47], a[120:127], v2
    ds_read_b128 v[64:67], v30 offset:0
    v_smfmac_f32_16x16x64_bf16 v[96:99], v[40:43], a[240:247], v2
    ds_read_b128 v[68:71], v30 offset:1024
    s_cbranch_vccnz L_flgw_n0
L_flg_n0:
    v_smfmac_f32_16x16x64_bf16 v[92:95], v[44:47], a[184:191], v2
    buffer_load_dwordx4 v[112:115], v1, s[8:11], s73 offen offset:1024 sc1
    ds_read_b128 v[72:75], v30 offset:2048
    s_mov_b32 m0, s75
    v_add_f32 v80, v80, v82
    v_smfmac_f32_16x16x64_bf16 v[96:99], v[44:47], a[248:255], v2
    ds_read_b128 v[76:79], v30 offset:3072
    v_add_f32 v81, v81, v83
    v_smfmac_f32_16x16x64_bf16 v[100:103], v[32:35], v[160:167], v2
    s_add_u32 s73, s73, 0x40000
    v_add_f32 v84, v84, v86
    v_add_f32 v85, v85, v87
    v_cvt_pk_bf16_f32 v28, v80, v84
    v_cvt_pk_bf16_f32 v29, v81, v85
    ds_write2_b32 v17, v28, v29 offset0:0 offset1:72
    v_add_f32 v92, v92, v94
    v_add_f32 v93, v93, v95
    v_add_f32 v96, v96, v98
    v_add_f32 v97, v97, v99
    v_cvt_pk_bf16_f32 v31, v92, v96
    v_cvt_pk_bf16_f32 v127, v93, v97
    ds_write2_b32 v126, v31, v127 offset0:0 offset1:72
    v_smfmac_f32_16x16x64_bf16 v[104:107], v[32:35], v[224:231], v2
    buffer_load_dwordx4 v1, s[8:11], s74 offen sc1 lds
    s_xor_b32 s75, s75, 0x2000
    v_smfmac_f32_16x16x64_bf16 v[100:103], v[36:39], v[168:175], v2
    buffer_load_dword v26, v121, s[8:11], s76 offen offset:256 sc1
    s_nop 0
    v_smfmac_f32_16x16x64_bf16 v[104:107], v[36:39], v[232:239], v2
    buffer_load_dwordx4 v1, s[8:11], s74 offen offset:1024 sc1 lds
    s_add_u32 s74, s74, 0x40000
    v_smfmac_f32_16x16x64_bf16 v[100:103], v[40:43], v[176:183], v2
    s_waitcnt lgkmcnt(0)
    s_barrier
    ds_read_b128 v[48:51], v18 offset:0
    ds_read_b128 v[52:55], v18 offset:64
    ds_read_b128 v[56:59], v18 offset:128
    ds_read_b128 v[60:63], v18 offset:192
    v_smfmac_f32_16x16x64_bf16 v[104:107], v[40:43], v[240:247], v2
    ds_read_b128 v[32:35], v30 offset:4096
    ds_read_b128 v[36:39], v30 offset:5120
    v_smfmac_f32_16x16x64_bf16 v[100:103], v[44:47], v[184:191], v2
    ds_read_b128 v[40:43], v30 offset:6144
    v_smfmac_f32_16x16x64_bf16 v[104:107], v[44:47], v[248:255], v2
    ds_read_b128 v[44:47], v30 offset:7168
    s_waitcnt lgkmcnt(7)
    v_mfma_f32_16x16x32_bf16 v[80:83], v[64:67], v[48:51], 0
    ds_read_b128 v[64:67], v19 offset:0
    s_waitcnt lgkmcnt(7)
    v_mfma_f32_16x16x32_bf16 v[80:83], v[68:71], v[52:55], v[80:83]
    ds_read_b128 v[68:71], v19 offset:64
    s_mov_b64 exec, 0xffff
    buffer_load_dword v31, v24, s[8:11], s73 offen sc1
    s_mov_b64 exec, -1
    s_waitcnt lgkmcnt(7)
    v_mfma_f32_16x16x32_bf16 v[80:83], v[72:75], v[56:59], v[80:83]
    ds_read_b128 v[72:75], v19 offset:128
    s_waitcnt lgkmcnt(7)
    v_mfma_f32_16x16x32_bf16 v[80:83], v[76:79], v[60:63], v[80:83]
    ds_read_b128 v[76:79], v19 offset:192
    s_add_u32 s76, s76, 128
    s_waitcnt lgkmcnt(4)
    v_mfma_f32_16x16x32_bf16 v[84:87], v[32:35], v[48:51], 0
    buffer_store_dword v27, v16, s[8:11], s77 offen sc1
    v_add_f32 v100, v100, v102
    v_add_f32 v101, v101, v103
    v_mfma_f32_16x16x32_bf16 v[84:87], v[36:39], v[52:55], v[84:87]
    s_add_u32 s77, s77, 0x4000
    v_cvt_pk_bf16_f32 v122, v100, v101
    v_add_f32 v104, v104, v106
    v_mfma_f32_16x16x32_bf16 v[84:87], v[40:43], v[56:59], v[84:87]
    v_add_f32 v105, v105, v107
    v_cvt_pk_bf16_f32 v124, v104, v105
    v_mfma_f32_16x16x32_bf16 v[84:87], v[44:47], v[60:63], v[84:87]
    s_waitcnt lgkmcnt(0)
    v_mfma_f32_16x16x32_bf16 v[88:91], v[64:67], v[48:51], 0
    ds_read_b128 v[32:35], v22 offset:0
    v_max3_f32 v28, v80, v81, v82
    s_add_u32 s29, s29, 1
    v_mfma_f32_16x16x32_bf16 v[88:91], v[68:71], v[52:55], v[88:91]
    ds_read_b128 v[36:39], v22 offset:1024
    s_and_b32 s68, s29, 3
    s_lshl_b32 s68, s68, 14
    v_mfma_f32_16x16x32_bf16 v[88:91], v[72:75], v[56:59], v[88:91]
    ds_read_b128 v[40:43], v22 offset:16384
    s_add_u32 s68, s68, 0x8190000
    s_xor_b32 s80, s80, 0x2000
    v_mfma_f32_16x16x32_bf16 v[88:91], v[76:79], v[60:63], v[88:91]
    ds_read_b128 v[44:47], v22 offset:17408
    v_max3_f32 v28, v28, v83, v84
    v_max3_f32 v28, v28, v85, v86
    v_max_f32 v28, v28, v87
    v_mov_b64 v[104:105], 0
    v_mov_b64 v[106:107], 0
    v_mov_b32 v127, v121
    v_mov_b32 v127, v121
    v_max3_f32 v28, v28, v88, v89
    v_mov_b32 v29, v28
    ds_read_b128 v[48:51], v22 offset:8192
    ds_read_b128 v[52:55], v22 offset:9216
    v_permlane32_swap_b32 v28, v29
    v_max_f32 v28, v28, v29
    v_mov_b32 v29, v28
    ds_read_b128 v[56:59], v22 offset:24576
    ds_read_b128 v[60:63], v22 offset:25600
    v_permlane16_swap_b32 v28, v29
    v_max_f32 v28, v28, v29
    v_mul_f32 v28, 0xbe0293ee, v28
    v_pk_fma_f32 v[88:89], v[88:89], s[58:59], v[28:29] op_sel_hi:[1,0,0]
    v_pk_fma_f32 v[80:81], v[80:81], s[58:59], v[28:29] op_sel_hi:[1,0,0]
    v_pk_fma_f32 v[82:83], v[82:83], s[58:59], v[28:29] op_sel_hi:[1,0,0]
    v_pk_fma_f32 v[84:85], v[84:85], s[58:59], v[28:29] op_sel_hi:[1,0,0]
    v_pk_fma_f32 v[86:87], v[86:87], s[58:59], v[28:29] op_sel_hi:[1,0,0]
    v_exp_f32 v88, v88
    v_exp_f32 v89, v89
    v_exp_f32 v80, v80
    v_cvt_pk_bf16_f32 v120, v88, v89
    v_exp_f32 v81, v81
    v_exp_f32 v82, v82
    v_mfma_f32_16x16x16_bf16 v[100:103], v[8:9], v[120:121], 0
    v_exp_f32 v83, v83
    v_cvt_pk_bf16_f32 v116, v80, v81
    v_mfma_f32_16x16x16_bf16 v[92:95], v[122:123], v[120:121], 0
    v_exp_f32 v84, v84
    v_cvt_pk_bf16_f32 v117, v82, v83
    v_mfma_f32_16x16x16_bf16 v[96:99], v[124:125], v[120:121], 0
    v_exp_f32 v85, v85
    v_exp_f32 v86, v86
    v_exp_f32 v87, v87
    v_cvt_pk_bf16_f32 v118, v84, v85
    v_cvt_pk_bf16_f32 v119, v86, v87
    s_waitcnt vmcnt(5)
    v_mov_b64 v[88:89], 0
    ds_read_b128 v[64:67], v22 offset:32768
    v_mfma_f32_16x16x32_bf16 v[100:103], v[8:11], v[116:119], v[100:103]
    ds_read_b128 v[68:71], v22 offset:33792
    v_mov_b64 v[90:91], 0
    v_mov_b64 v[84:85], 0
    v_mfma_f32_16x16x32_bf16 v[92:95], v[108:111], v[116:119], v[92:95]
    ds_read_b128 v[72:75], v22 offset:49152
    v_mov_b64 v[86:87], 0
    v_mov_b64 v[80:81], 0
    v_mfma_f32_16x16x32_bf16 v[96:99], v[112:115], v[116:119], v[96:99]
    ds_read_b128 v[76:79], v22 offset:50176
    v_mov_b64 v[82:83], 0
    v_rcp_f32 v28, v100
    s_nop 4
    v_cndmask_b32 v92, v92, v96, s[60:61]
    v_cndmask_b32 v93, v93, v97, s[60:61]
    v_cndmask_b32 v94, v94, v98, s[60:61]
    v_cndmask_b32 v95, v95, v99, s[60:61]
    v_mul_f32 v92, v92, v28
    v_mul_f32 v93, v93, v28
    v_mul_f32 v94, v94, v28
    v_mul_f32 v95, v95, v28
    v_cvt_pk_bf16_f32 v116, v92, v93
    v_cvt_pk_bf16_f32 v117, v94, v95
    ds_write_b64 v20, v[116:117]
    v_mov_b64 v[100:101], 0
    s_nop 1
    v_mov_b64 v[102:103], 0
    s_nop 1
    v_mov_b64 v[92:93], 0
    s_nop 1
    s_waitcnt lgkmcnt(0)
    s_barrier
    ds_read_b128 v[108:111], v21 offset:29184
    ds_read_b128 v[112:115], v21 offset:30208
    v_mov_b64 v[116:117], 0
    v_mov_b64 v[118:119], 0
    v_mov_b64 v[94:95], 0
    v_mov_b64 v[96:97], 0
    v_mov_b64 v[98:99], 0
    s_waitcnt lgkmcnt(0)
    v_smfmac_f32_16x16x64_bf16 v[116:119], v[108:111], v[32:39], v2
    ds_read_b128 v[32:35], v22 offset:40960
    ds_read_b128 v[36:39], v22 offset:41984
    v_smfmac_f32_16x16x64_bf16 v[116:119], v[112:115], v[40:47], v2
    ds_read_b128 v[40:43], v22 offset:57344
    ds_read_b128 v[44:47], v22 offset:58368
    v_smfmac_f32_16x16x64_bf16 v[88:91], v[108:111], v[48:55], v2
    ds_read_b128 v[48:51], v23 offset:0
    ds_read_b128 v[52:55], v23 offset:1024
    v_smfmac_f32_16x16x64_bf16 v[88:91], v[112:115], v[56:63], v2
    ds_read_b128 v[56:59], v23 offset:16384
    ds_read_b128 v[60:63], v23 offset:17408
    v_add_f32 v116, v116, v118
    v_add_f32 v117, v117, v119
    v_cvt_pk_bf16_f32 v28, v116, v117
    v_bfi_b32 v28, v0, s50, v28
    v_smfmac_f32_16x16x64_bf16 v[84:87], v[108:111], v[64:71], v2
    buffer_store_dword v28, v13, s[8:11], s70 offen offset:0
    ds_read_b128 v[64:67], v23 offset:8192
    ds_read_b128 v[68:71], v23 offset:9216
    v_smfmac_f32_16x16x64_bf16 v[84:87], v[112:115], v[72:79], v2
    ds_read_b128 v[72:75], v23 offset:24576
    ds_read_b128 v[76:79], v23 offset:25600
    v_add_f32 v88, v88, v90
    v_add_f32 v89, v89, v91
    v_cvt_pk_bf16_f32 v29, v88, v89
    v_bfi_b32 v29, v0, s50, v29
    s_waitcnt lgkmcnt(8)
    v_smfmac_f32_16x16x64_bf16 v[104:107], v[108:111], v[32:39], v2
    buffer_store_dword v29, v13, s[8:11], s70 offen offset:256
    ds_read_b128 v[32:35], v23 offset:32768
    ds_read_b128 v[36:39], v23 offset:33792
    v_smfmac_f32_16x16x64_bf16 v[104:107], v[112:115], v[40:47], v2
    ds_read_b128 v[40:43], v23 offset:49152
    ds_read_b128 v[44:47], v23 offset:50176
    v_add_f32 v84, v84, v86
    v_add_f32 v85, v85, v87
    v_cvt_pk_bf16_f32 v28, v84, v85
    v_bfi_b32 v28, v0, s50, v28
    s_waitcnt lgkmcnt(8)
    v_smfmac_f32_16x16x64_bf16 v[80:83], v[108:111], v[48:55], v2
    buffer_store_dword v28, v13, s[8:11], s70 offen offset:512
    ds_read_b128 v[48:51], v23 offset:40960
    ds_read_b128 v[52:55], v23 offset:41984
    v_smfmac_f32_16x16x64_bf16 v[80:83], v[112:115], v[56:63], v2
    ds_read_b128 v[56:59], v23 offset:57344
    ds_read_b128 v[60:63], v23 offset:58368
    v_add_f32 v104, v104, v106
    v_add_f32 v105, v105, v107
    v_cvt_pk_bf16_f32 v29, v104, v105
    v_bfi_b32 v29, v0, s50, v29
    s_waitcnt lgkmcnt(8)
    v_smfmac_f32_16x16x64_bf16 v[100:103], v[108:111], v[64:71], v2
    buffer_store_dword v29, v13, s[8:11], s70 offen offset:768
    s_add_u32 s44, s68, s51
    v_smfmac_f32_16x16x64_bf16 v[100:103], v[112:115], v[72:79], v2
    s_add_u32 s45, s68, s42
    v_add_f32 v80, v80, v82
    v_add_f32 v81, v81, v83
    v_cvt_pk_bf16_f32 v28, v80, v81
    v_bfi_b32 v28, v0, s50, v28
    s_waitcnt lgkmcnt(4)
    v_smfmac_f32_16x16x64_bf16 v[92:95], v[108:111], v[32:39], v2
    buffer_store_dword v28, v13, s[8:11], s70 offen offset:1024
    v_smfmac_f32_16x16x64_bf16 v[92:95], v[112:115], v[40:47], v2
    ds_write2st64_b32 v3, v12, v12 offset0:0 offset1:4
    v_add_f32 v100, v100, v102
    v_add_f32 v101, v101, v103
    v_cvt_pk_bf16_f32 v29, v100, v101
    v_bfi_b32 v29, v0, s50, v29
    s_waitcnt lgkmcnt(1)
    v_smfmac_f32_16x16x64_bf16 v[96:99], v[108:111], v[48:55], v2
    buffer_store_dword v29, v13, s[8:11], s70 offen offset:1280
    v_smfmac_f32_16x16x64_bf16 v[96:99], v[112:115], v[56:63], v2
    v_add_f32 v92, v92, v94
    v_add_f32 v93, v93, v95
    v_cvt_pk_bf16_f32 v28, v92, v93
    v_bfi_b32 v28, v0, s50, v28
    buffer_store_dword v28, v13, s[8:11], s70 offen offset:1536
    s_mov_b32 m0, s69
    v_mov_b64 v[84:85], 0
    v_mov_b64 v[86:87], 0
    v_add_f32 v96, v96, v98
    v_add_f32 v97, v97, v99
    v_cvt_pk_bf16_f32 v29, v96, v97
    v_bfi_b32 v29, v0, s50, v29
    buffer_store_dword v29, v13, s[8:11], s70 offen offset:1792
    s_waitcnt lgkmcnt(0)
    s_barrier
    s_cmp_lt_u32 s64, 2
    s_cbranch_scc1 L_nored_n0
    s_mov_b32 s40, s63
    s_sub_u32 s40, s40, 1
    s_cbranch_scc1 L_gath_n0
    s_nop 1
    s_sub_u32 s40, s40, 1
    s_cbranch_scc1 L_gath_n0
    s_nop 1
    s_sub_u32 s40, s40, 1
    s_cbranch_scc1 L_gath_n0
    s_nop 1
    s_sub_u32 s40, s40, 1
    s_cbranch_scc1 L_gath_n0
    s_nop 1
    s_sub_u32 s40, s40, 1
    s_cbranch_scc1 L_gath_n0
    s_nop 1
    s_sub_u32 s40, s40, 1
    s_cbranch_scc1 L_gath_n0
    s_nop 1
    s_sub_u32 s40, s40, 1
    s_cbranch_scc1 L_gath_n0
    s_nop 1
    s_sub_u32 s40, s40, 1
    s_cbranch_scc1 L_gath_n0
    s_nop 1
    s_sub_u32 s40, s40, 1
    s_cbranch_scc1 L_gath_n0
    s_nop 1
    s_sub_u32 s40, s40, 1
    s_cbranch_scc1 L_gath_n0
    s_nop 1
    s_sub_u32 s40, s40, 1
    s_cbranch_scc1 L_gath_n0
    s_nop 1
    s_sub_u32 s40, s40, 1
    s_cbranch_scc1 L_gath_n0
    s_nop 1
    s_sub_u32 s40, s40, 1
    s_cbranch_scc1 L_gath_n0
    s_nop 1
    s_sub_u32 s40, s40, 1
    s_cbranch_scc1 L_gath_n0
    s_nop 1
    s_sub_u32 s40, s40, 1
    s_cbranch_scc1 L_gath_n0
    s_nop 1
    s_sub_u32 s40, s40, 1
    s_cbranch_scc1 L_gath_n0
    s_nop 1
    s_sub_u32 s40, s40, 1
    s_cbranch_scc1 L_gath_n0
    s_nop 1
    s_sub_u32 s40, s40, 1
    s_cbranch_scc1 L_gath_n0
    s_nop 1
    s_sub_u32 s40, s40, 1
    s_cbranch_scc1 L_gath_n0
    s_nop 1
    s_sub_u32 s40, s40, 1
    s_cbranch_scc1 L_gath_n0
    s_nop 1
    s_sub_u32 s40, s40, 1
    s_cbranch_scc1 L_gath_n0
    s_nop 1
    s_sub_u32 s40, s40, 1
    s_cbranch_scc1 L_gath_n0
    s_nop 1
    s_sub_u32 s40, s40, 1
    s_cbranch_scc1 L_gath_n0
    s_nop 1
    s_sub_u32 s40, s40, 1
    s_cbranch_scc1 L_gath_n0
    s_nop 1
L_gath_n0:
    buffer_load_dwordx4 v[64:67], v14, s[8:11], s70 offen sc1
    buffer_load_dwordx4 v[68:71], v14, s[8:11], s71 offen sc1
    buffer_load_dwordx4 v[72:75], v14, s[8:11], s72 offen sc1
    buffer_load_dwordx4 v[76:79], v14, s[8:11], s62 offen sc1
    v_mov_b64 v[104:105], 0
    v_mov_b64 v[106:107], 0
    v_mov_b64 v[80:81], 0
    v_mov_b64 v[82:83], 0
    v_mov_b64 v[100:101], 0
    v_mov_b64 v[102:103], 0
    v_mov_b64 v[92:93], 0
    v_mov_b64 v[94:95], 0
    v_mov_b64 v[96:97], 0
    v_mov_b64 v[98:99], 0
L_chk_n0:
    s_waitcnt vmcnt(3)
    v_mfma_f32_16x16x32_bf16 v[32:35], v[4:7], v[64:67], 0
    v_and_b32 v28, 1, v64
    v_cmp_ne_u32 s[46:47], s50, v28
    s_waitcnt vmcnt(2)
    v_mfma_f32_16x16x32_bf16 v[32:35], v[4:7], v[68:71], v[32:35]
    v_and_b32 v28, 1, v68
    v_cmp_ne_u32 s[48:49], s50, v28
    s_waitcnt vmcnt(1)
    v_mfma_f32_16x16x32_bf16 v[32:35], v[4:7], v[72:75], v[32:35]
    v_and_b32 v28, 1, v72
    v_cmp_ne_u32 s[4:5], s50, v28
    s_waitcnt vmcnt(0)
    v_mfma_f32_16x16x32_bf16 v[32:35], v[4:7], v[76:79], v[32:35]
    v_and_b32 v28, 1, v76
    v_cmp_ne_u32 s[6:7], s50, v28
    s_or_b64 vcc, s[46:47], s[48:49]
    s_or_b64 vcc, vcc, s[4:5]
    s_or_b64 vcc, vcc, s[6:7]
    s_cbranch_scc1 L_redb_n0
    s_nop 1
    v_add_f32_dpp v32, v32, v32 row_ror:8 row_mask:0xf bank_mask:0xf
    v_add_f32_dpp v33, v33, v33 row_ror:8 row_mask:0xf bank_mask:0xf
    v_cvt_pk_bf16_f32 v27, v32, v33
    buffer_store_dword v27, v16, s[8:11], s68 offen
    s_add_u32 s78, s29, 3
    s_and_b32 s78, s78, 3
    s_lshl_b32 s78, s78, 14
    s_add_u32 s78, s78, 0x8190000
    s_bfe_u32 s50, s29, 0x10001
    s_xor_b32 s70, s70, 294912
    s_xor_b32 s71, s71, 294912
    s_xor_b32 s72, s72, 360448
    s_xor_b32 s62, s62, 360448
    s_mov_b64 s[46:47], -1
    s_mov_b64 s[48:49], -1
    s_cmp_lt_u32 s29, 63
    s_cbranch_scc1 L_step_n0
    s_branch L_fin_n0
L_nored_n0:
    v_mov_b64 v[104:105], 0
    v_mov_b64 v[106:107], 0
    v_mov_b64 v[80:81], 0
    v_mov_b64 v[82:83], 0
    v_mov_b64 v[100:101], 0
    v_mov_b64 v[102:103], 0
    v_mov_b64 v[92:93], 0
    v_mov_b64 v[94:95], 0
    v_mov_b64 v[96:97], 0
    v_mov_b64 v[98:99], 0
    s_add_u32 s78, s29, 3
    s_and_b32 s78, s78, 3
    s_lshl_b32 s78, s78, 14
    s_add_u32 s78, s78, 0x8190000
    s_bfe_u32 s50, s29, 0x10001
    s_xor_b32 s70, s70, 294912
    s_xor_b32 s71, s71, 294912
    s_xor_b32 s72, s72, 360448
    s_xor_b32 s62, s62, 360448
    s_mov_b64 s[46:47], -1
    s_mov_b64 s[48:49], -1
    s_cmp_lt_u32 s29, 63
    s_cbranch_scc1 L_step_n0
L_fin_n0:
    buffer_store_dword v27, v16, s[8:11], s77 offen sc1
    s_endpgm
L_rty2_n0:
    ds_read_b128 v[48:51], v21 offset:17408
    ds_read2st64_b32 v[28:29], v3 offset0:0 offset1:4
L_rtl2_n0:
    ds_read_b128 v[40:43], v21 offset:17408
    v_mov_b32 v127, v121
    s_waitcnt lgkmcnt(1)
    v_cmp_eq_u32 vcc, -1, v48
    v_cmp_eq_u32 s[46:47], -1, v28
    v_cmp_eq_u32 s[48:49], -1, v29
    s_mov_b64 exec, s[46:47]
    buffer_load_dwordx4 v25, s[8:11], s44 offen sc1 lds
    s_mov_b64 exec, s[48:49]
    buffer_load_dwordx4 v25, s[8:11], s45 offen offset:1024 sc1 lds
    s_mov_b64 exec, -1
    s_cbranch_vccz L_rtx2_n0
    ds_read_b128 v[48:51], v21 offset:17408
    ds_read2st64_b32 v[28:29], v3 offset0:0 offset1:4
    s_sub_u32 s28, s28, 1
    s_cbranch_scc1 L_fail
    s_waitcnt lgkmcnt(2)
    v_cmp_eq_u32 vcc, -1, v40
    s_nop 1
    v_mov_b32 v127, v121
    s_nop 1
    v_mov_b32 v127, v121
    s_cbranch_vccnz L_rtl2_n0
L_rtx2_n0:
    s_waitcnt lgkmcnt(0)
    s_branch L_go2_n0
L_rty3_n0:
    ds_read_b128 v[48:51], v21 offset:19456
    ds_read2st64_b32 v[28:29], v3 offset0:0 offset1:4
L_rtl3_n0:
    ds_read_b128 v[44:47], v21 offset:19456
    v_mov_b32 v127, v121
    s_waitcnt lgkmcnt(1)
    v_cmp_eq_u32 vcc, -1, v48
    v_cmp_eq_u32 s[46:47], -1, v28
    v_cmp_eq_u32 s[48:49], -1, v29
    s_mov_b64 exec, s[46:47]
    buffer_load_dwordx4 v25, s[8:11], s44 offen sc1 lds
    s_mov_b64 exec, s[48:49]
    buffer_load_dwordx4 v25, s[8:11], s45 offen offset:1024 sc1 lds
    s_mov_b64 exec, -1
    s_cbranch_vccz L_rtx3_n0
    ds_read_b128 v[48:51], v21 offset:19456
    ds_read2st64_b32 v[28:29], v3 offset0:0 offset1:4
    s_sub_u32 s28, s28, 1
    s_cbranch_scc1 L_fail
    s_waitcnt lgkmcnt(2)
    v_cmp_eq_u32 vcc, -1, v44
    s_nop 1
    v_mov_b32 v127, v121
    s_nop 1
    v_mov_b32 v127, v121
    s_cbranch_vccnz L_rtl3_n0
L_rtx3_n0:
    s_waitcnt lgkmcnt(0)
    s_branch L_go3_n0
L_rty4_n0:
    ds_read_b128 v[48:51], v21 offset:20480
    ds_read2st64_b32 v[28:29], v3 offset0:0 offset1:4
L_rtl4_n0:
    ds_read_b128 v[32:35], v21 offset:20480
    v_mov_b32 v127, v121
    s_waitcnt lgkmcnt(1)
    v_cmp_eq_u32 vcc, -1, v48
    v_cmp_eq_u32 s[46:47], -1, v28
    v_cmp_eq_u32 s[48:49], -1, v29
    s_mov_b64 exec, s[46:47]
    buffer_load_dwordx4 v25, s[8:11], s44 offen sc1 lds
    s_mov_b64 exec, s[48:49]
    buffer_load_dwordx4 v25, s[8:11], s45 offen offset:1024 sc1 lds
    s_mov_b64 exec, -1
    s_cbranch_vccz L_rtx4_n0
    ds_read_b128 v[48:51], v21 offset:20480
    ds_read2st64_b32 v[28:29], v3 offset0:0 offset1:4
    s_sub_u32 s28, s28, 1
    s_cbranch_scc1 L_fail
    s_waitcnt lgkmcnt(2)
    v_cmp_eq_u32 vcc, -1, v32
    s_nop 1
    v_mov_b32 v127, v121
    s_nop 1
    v_mov_b32 v127, v121
    s_cbranch_vccnz L_rtl4_n0
L_rtx4_n0:
    s_waitcnt lgkmcnt(0)
    s_branch L_go4_n0
L_rty5_n0:
    ds_read_b128 v[48:51], v21 offset:22528
    ds_read2st64_b32 v[28:29], v3 offset0:0 offset1:4
L_rtl5_n0:
    ds_read_b128 v[36:39], v21 offset:22528
    v_mov_b32 v127, v121
    s_waitcnt lgkmcnt(1)
    v_cmp_eq_u32 vcc, -1, v48
    v_cmp_eq_u32 s[46:47], -1, v28
    v_cmp_eq_u32 s[48:49], -1, v29
    s_mov_b64 exec, s[46:47]
    buffer_load_dwordx4 v25, s[8:11], s44 offen sc1 lds
    s_mov_b64 exec, s[48:49]
    buffer_load_dwordx4 v25, s[8:11], s45 offen offset:1024 sc1 lds
    s_mov_b64 exec, -1
    s_cbranch_vccz L_rtx5_n0
    ds_read_b128 v[48:51], v21 offset:22528
    ds_read2st64_b32 v[28:29], v3 offset0:0 offset1:4
    s_sub_u32 s28, s28, 1
    s_cbranch_scc1 L_fail
    s_waitcnt lgkmcnt(2)
    v_cmp_eq_u32 vcc, -1, v36
    s_nop 1
    v_mov_b32 v127, v121
    s_nop 1
    v_mov_b32 v127, v121
    s_cbranch_vccnz L_rtl5_n0
L_rtx5_n0:
    s_waitcnt lgkmcnt(0)
    s_branch L_go5_n0
L_rty6_n0:
    ds_read_b128 v[48:51], v21 offset:21504
    ds_read2st64_b32 v[28:29], v3 offset0:0 offset1:4
L_rtl6_n0:
    ds_read_b128 v[40:43], v21 offset:21504
    v_mov_b32 v127, v121
    s_waitcnt lgkmcnt(1)
    v_cmp_eq_u32 vcc, -1, v48
    v_cmp_eq_u32 s[46:47], -1, v28
    v_cmp_eq_u32 s[48:49], -1, v29
    s_mov_b64 exec, s[46:47]
    buffer_load_dwordx4 v25, s[8:11], s44 offen sc1 lds
    s_mov_b64 exec, s[48:49]
    buffer_load_dwordx4 v25, s[8:11], s45 offen offset:1024 sc1 lds
    s_mov_b64 exec, -1
    s_cbranch_vccz L_rtx6_n0
    ds_read_b128 v[48:51], v21 offset:21504
    ds_read2st64_b32 v[28:29], v3 offset0:0 offset1:4
    s_sub_u32 s28, s28, 1
    s_cbranch_scc1 L_fail
    s_waitcnt lgkmcnt(2)
    v_cmp_eq_u32 vcc, -1, v40
    s_nop 1
    v_mov_b32 v127, v121
    s_nop 1
    v_mov_b32 v127, v121
    s_cbranch_vccnz L_rtl6_n0
L_rtx6_n0:
    s_waitcnt lgkmcnt(0)
    s_branch L_go6_n0
L_rty7_n0:
    ds_read_b128 v[48:51], v21 offset:23552
    ds_read2st64_b32 v[28:29], v3 offset0:0 offset1:4
L_rtl7_n0:
    ds_read_b128 v[44:47], v21 offset:23552
    v_mov_b32 v127, v121
    s_waitcnt lgkmcnt(1)
    v_cmp_eq_u32 vcc, -1, v48
    v_cmp_eq_u32 s[46:47], -1, v28
    v_cmp_eq_u32 s[48:49], -1, v29
    s_mov_b64 exec, s[46:47]
    buffer_load_dwordx4 v25, s[8:11], s44 offen sc1 lds
    s_mov_b64 exec, s[48:49]
    buffer_load_dwordx4 v25, s[8:11], s45 offen offset:1024 sc1 lds
    s_mov_b64 exec, -1
    s_cbranch_vccz L_rtx7_n0
    ds_read_b128 v[48:51], v21 offset:23552
    ds_read2st64_b32 v[28:29], v3 offset0:0 offset1:4
    s_sub_u32 s28, s28, 1
    s_cbranch_scc1 L_fail
    s_waitcnt lgkmcnt(2)
    v_cmp_eq_u32 vcc, -1, v44
    s_nop 1
    v_mov_b32 v127, v121
    s_nop 1
    v_mov_b32 v127, v121
    s_cbranch_vccnz L_rtl7_n0
L_rtx7_n0:
    s_waitcnt lgkmcnt(0)
    s_branch L_go7_n0
L_flgw_n0:
    s_sub_u32 s28, s28, 1
    s_cbranch_scc1 L_fail
    s_sleep 1
    buffer_load_dword v26, v121, s[8:11], s76 offen offset:128 sc1
    s_waitcnt vmcnt(0)
    v_cmp_eq_u32 vcc, -1, v26
    s_cbranch_vccnz L_flgw_n0
    s_branch L_flg_n0
L_redb_n0:
    s_mov_b64 exec, s[46:47]
    buffer_load_dwordx4 v[64:67], v14, s[8:11], s70 offen sc1
    s_mov_b64 exec, s[48:49]
    buffer_load_dwordx4 v[68:71], v14, s[8:11], s71 offen sc1
    s_mov_b64 exec, s[4:5]
    buffer_load_dwordx4 v[72:75], v14, s[8:11], s72 offen sc1
    s_mov_b64 exec, s[6:7]
    buffer_load_dwordx4 v[76:79], v14, s[8:11], s62 offen sc1
    s_mov_b64 exec, -1
    s_sub_u32 s28, s28, 1
    s_cbranch_scc1 L_fail
    s_branch L_chk_n0
L_chain_far:
    s_mov_b32 m0, s69
    s_nop 0
    buffer_load_dwordx4 v25, s[8:11], s44 offen sc1 lds
    buffer_load_dwordx4 v25, s[8:11], s45 offen offset:1024 sc1 lds
    s_mov_b64 s[46:47], -1
    s_mov_b64 s[48:49], -1
    s_barrier
L_step_f:
    ds_read_b128 v[32:35], v21 offset:16384
    ds_read_b128 v[36:39], v21 offset:18432
    ds_read_b128 v[48:51], v21 offset:16384
    ds_read_b128 v[52:55], v21 offset:18432
    ds_read2st64_b32 v[30:31], v3 offset0:0 offset1:4
    s_waitcnt lgkmcnt(3)
    v_max_u32 v28, v32, v36
    v_cmp_eq_u32 vcc, -1, v28
    s_cbranch_vccz L_got_f
    ds_read_b128 v[32:35], v21 offset:16384
    ds_read_b128 v[36:39], v21 offset:18432
    s_waitcnt lgkmcnt(2)
    v_max_u32 v28, v48, v52
    v_cmp_eq_u32 vcc, -1, v28
    v_cmp_eq_u32 s[46:47], -1, v30
    v_cmp_eq_u32 s[48:49], -1, v31
    s_cbranch_vccz L_gotb_f
    ds_read_b128 v[48:51], v21 offset:16384
    ds_read_b128 v[52:55], v21 offset:18432
    ds_read2st64_b32 v[30:31], v3 offset0:0 offset1:4
    s_mov_b64 exec, s[46:47]
    buffer_load_dwordx4 v25, s[8:11], s44 offen sc1 lds
    s_mov_b64 exec, s[48:49]
    buffer_load_dwordx4 v25, s[8:11], s45 offen offset:1024 sc1 lds
    s_mov_b64 exec, -1
    s_waitcnt lgkmcnt(3)
    v_max_u32 v28, v32, v36
    v_cmp_eq_u32 vcc, -1, v28
    s_cbranch_vccz L_got_f
    ds_read_b128 v[32:35], v21 offset:16384
    ds_read_b128 v[36:39], v21 offset:18432
    s_waitcnt lgkmcnt(2)
    v_max_u32 v28, v48, v52
    v_cmp_eq_u32 vcc, -1, v28
    v_cmp_eq_u32 s[46:47], -1, v30
    v_cmp_eq_u32 s[48:49], -1, v31
    s_cbranch_vccz L_gotb_f
L_spin_f:
    s_sub_u32 s28, s28, 1
    s_cbranch_scc1 L_fail
    ds_read_b128 v[48:51], v21 offset:16384
    ds_read_b128 v[52:55], v21 offset:18432
    s_mov_b64 exec, s[46:47]
    buffer_load_dwordx4 v25, s[8:11], s44 offen sc1 lds
    s_mov_b64 exec, s[48:49]
    buffer_load_dwordx4 v25, s[8:11], s45 offen offset:1024 sc1 lds
    s_mov_b64 exec, -1
    s_waitcnt lgkmcnt(2)
    v_max_u32 v28, v32, v36
    v_cmp_eq_u32 vcc, -1, v28
    s_cbranch_vccz L_got_f
    ds_read_b128 v[32:35], v21 offset:16384
    ds_read_b128 v[36:39], v21 offset:18432
    s_waitcnt lgkmcnt(2)
    v_max_u32 v28, v48, v52
    v_cmp_eq_u32 vcc, -1, v28
    s_cbranch_vccz L_gotb_f
    ds_read_b128 v[48:51], v21 offset:16384
    ds_read_b128 v[52:55], v21 offset:18432
    ds_read2st64_b32 v[30:31], v3 offset0:0 offset1:4
    s_waitcnt lgkmcnt(3)
    v_max_u32 v28, v32, v36
    v_cmp_eq_u32 vcc, -1, v28
    s_cbranch_vccz L_got_f
    ds_read_b128 v[32:35], v21 offset:16384
    ds_read_b128 v[36:39], v21 offset:18432
    s_waitcnt lgkmcnt(2)
    v_max_u32 v28, v48, v52
    v_cmp_eq_u32 vcc, -1, v28
    v_cmp_eq_u32 s[46:47], -1, v30
    v_cmp_eq_u32 s[48:49], -1, v31
    s_cbranch_vccnz L_spin_f
L_gotb_f:
    s_waitcnt lgkmcnt(0)
L_got_f:
L_go0_f:
    v_smfmac_f32_16x16x64_bf16 v[80:83], v[32:35], a[0:7], v2
    s_mov_b64 exec, s[46:47]
    buffer_load_dwordx4 v25, s[8:11], s44 offen sc1 lds
    s_mov_b64 exec, s[48:49]
    buffer_load_dwordx4 v25, s[8:11], s45 offen offset:1024 sc1 lds
    s_mov_b64 exec, -1
    v_smfmac_f32_16x16x64_bf16 v[84:87], v[32:35], a[64:71], v2
    v_smfmac_f32_16x16x64_bf16 v[92:95], v[32:35], a[128:135], v2
    v_smfmac_f32_16x16x64_bf16 v[96:99], v[32:35], a[192:199], v2
    v_smfmac_f32_16x16x64_bf16 v[100:103], v[32:35], v[128:135], v2
    v_smfmac_f32_16x16x64_bf16 v[104:107], v[32:35], v[192:199], v2
    ds_read_b128 v[40:43], v21 offset:17408
L_go1_f:
    v_smfmac_f32_16x16x64_bf16 v[80:83], v[36:39], a[8:15], v2
    s_mov_b64 exec, s[46:47]
    buffer_load_dwordx4 v25, s[8:11], s44 offen sc1 lds
    s_mov_b64 exec, s[48:49]
    buffer_load_dwordx4 v25, s[8:11], s45 offen offset:1024 sc1 lds
    s_mov_b64 exec, -1
    v_smfmac_f32_16x16x64_bf16 v[84:87], v[36:39], a[72:79], v2
    v_smfmac_f32_16x16x64_bf16 v[92:95], v[36:39], a[136:143], v2
    v_smfmac_f32_16x16x64_bf16 v[96:99], v[36:39], a[200:207], v2
    s_waitcnt lgkmcnt(0)
    v_cmp_eq_u32 vcc, -1, v40
    v_smfmac_f32_16x16x64_bf16 v[100:103], v[36:39], v[136:143], v2
    v_smfmac_f32_16x16x64_bf16 v[104:107], v[36:39], v[200:207], v2
    ds_read_b128 v[44:47], v21 offset:19456
    s_cbranch_vccnz L_rty2_f
L_go2_f:
    v_smfmac_f32_16x16x64_bf16 v[80:83], v[40:43], a[16:23], v2
    v_smfmac_f32_16x16x64_bf16 v[84:87], v[40:43], a[80:87], v2
    v_smfmac_f32_16x16x64_bf16 v[92:95], v[40:43], a[144:151], v2
    v_smfmac_f32_16x16x64_bf16 v[96:99], v[40:43], a[208:215], v2
    s_waitcnt lgkmcnt(0)
    v_cmp_eq_u32 vcc, -1, v44
    v_smfmac_f32_16x16x64_bf16 v[100:103], v[40:43], v[144:151], v2
    v_smfmac_f32_16x16x64_bf16 v[104:107], v[40:43], v[208:215], v2
    ds_read_b128 v[32:35], v21 offset:20480
    s_cbranch_vccnz L_rty3_f
L_go3_f:
    v_smfmac_f32_16x16x64_bf16 v[80:83], v[44:47], a[24:31], v2
    v_smfmac_f32_16x16x64_bf16 v[84:87], v[44:47], a[88:95], v2
    v_smfmac_f32_16x16x64_bf16 v[92:95], v[44:47], a[152:159], v2
    v_smfmac_f32_16x16x64_bf16 v[96:99], v[44:47], a[216:223], v2
    s_waitcnt lgkmcnt(0)
    v_cmp_eq_u32 vcc, -1, v32
    v_smfmac_f32_16x16x64_bf16 v[100:103], v[44:47], v[152:159], v2
    ds_read_b128 v[36:39], v21 offset:22528
    v_smfmac_f32_16x16x64_bf16 v[104:107], v[44:47], v[216:223], v2
    s_cbranch_vccnz L_rty4_f
L_go4_f:
    v_smfmac_f32_16x16x64_bf16 v[80:83], v[32:35], a[32:39], v2
    ds_read_b128 v[40:43], v21 offset:21504
    v_smfmac_f32_16x16x64_bf16 v[84:87], v[32:35], a[96:103], v2
    s_waitcnt lgkmcnt(1)
    v_cmp_eq_u32 vcc, -1, v36
    v_smfmac_f32_16x16x64_bf16 v[92:95], v[32:35], a[160:167], v2
    v_smfmac_f32_16x16x64_bf16 v[96:99], v[32:35], a[224:231], v2
    buffer_store_dword v12, v16, s[8:11], s78 offen sc1
    s_cbranch_vccnz L_rty5_f
L_go5_f:
    v_smfmac_f32_16x16x64_bf16 v[80:83], v[36:39], a[40:47], v2
    ds_read_b128 v[44:47], v21 offset:23552
    v_smfmac_f32_16x16x64_bf16 v[84:87], v[36:39], a[104:111], v2
    s_waitcnt lgkmcnt(1)
    v_cmp_eq_u32 vcc, -1, v40
    v_smfmac_f32_16x16x64_bf16 v[92:95], v[36:39], a[168:175], v2
    v_smfmac_f32_16x16x64_bf16 v[96:99], v[36:39], a[232:239], v2
    s_cbranch_vccnz L_rty6_f
L_go6_f:
    v_smfmac_f32_16x16x64_bf16 v[80:83], v[40:43], a[48:55], v2
    s_waitcnt lgkmcnt(0)
    v_cmp_eq_u32 vcc, -1, v44
    v_smfmac_f32_16x16x64_bf16 v[84:87], v[40:43], a[112:119], v2
    v_smfmac_f32_16x16x64_bf16 v[92:95], v[40:43], a[176:183], v2
    v_add_u32 v30, s80, v21
    s_cbranch_vccnz L_rty7_f
L_go7_f:
    v_smfmac_f32_16x16x64_bf16 v[80:83], v[44:47], a[56:63], v2
    buffer_load_dwordx4 v[108:111], v1, s[8:11], s73 offen sc1
    v_cmp_eq_u32 vcc, -1, v26
    v_smfmac_f32_16x16x64_bf16 v[84:87], v[44:47], a[120:127], v2
    ds_read_b128 v[64:67], v30 offset:0
    v_smfmac_f32_16x16x64_bf16 v[96:99], v[40:43], a[240:247], v2
    ds_read_b128 v[68:71], v30 offset:1024
    s_cbranch_vccnz L_flgw_f
L_flg_f:
    v_smfmac_f32_16x16x64_bf16 v[92:95], v[44:47], a[184:191], v2
    buffer_load_dwordx4 v[112:115], v1, s[8:11], s73 offen offset:1024 sc1
    ds_read_b128 v[72:75], v30 offset:2048
    s_mov_b32 m0, s75
    v_add_f32 v80, v80, v82
    v_smfmac_f32_16x16x64_bf16 v[96:99], v[44:47], a[248:255], v2
    ds_read_b128 v[76:79], v30 offset:3072
    v_add_f32 v81, v81, v83
    v_smfmac_f32_16x16x64_bf16 v[100:103], v[32:35], v[160:167], v2
    s_add_u32 s73, s73, 0x40000
    v_add_f32 v84, v84, v86
    v_add_f32 v85, v85, v87
    v_cvt_pk_bf16_f32 v28, v80, v84
    v_cvt_pk_bf16_f32 v29, v81, v85
    ds_write2_b32 v17, v28, v29 offset0:0 offset1:72
    v_add_f32 v92, v92, v94
    v_add_f32 v93, v93, v95
    v_add_f32 v96, v96, v98
    v_add_f32 v97, v97, v99
    v_cvt_pk_bf16_f32 v31, v92, v96
    v_cvt_pk_bf16_f32 v127, v93, v97
    ds_write2_b32 v126, v31, v127 offset0:0 offset1:72
    v_smfmac_f32_16x16x64_bf16 v[104:107], v[32:35], v[224:231], v2
    buffer_load_dwordx4 v1, s[8:11], s74 offen sc1 lds
    s_xor_b32 s75, s75, 0x2000
    v_smfmac_f32_16x16x64_bf16 v[100:103], v[36:39], v[168:175], v2
    buffer_load_dword v26, v121, s[8:11], s76 offen offset:256 sc1
    s_nop 0
    v_smfmac_f32_16x16x64_bf16 v[104:107], v[36:39], v[232:239], v2
    buffer_load_dwordx4 v1, s[8:11], s74 offen offset:1024 sc1 lds
    s_add_u32 s74, s74, 0x40000
    v_smfmac_f32_16x16x64_bf16 v[100:103], v[40:43], v[176:183], v2
    s_waitcnt lgkmcnt(0)
    s_barrier
    ds_read_b128 v[48:51], v18 offset:0
    ds_read_b128 v[52:55], v18 offset:64
    ds_read_b128 v[56:59], v18 offset:128
    ds_read_b128 v[60:63], v18 offset:192
    v_smfmac_f32_16x16x64_bf16 v[104:107], v[40:43], v[240:247], v2
    ds_read_b128 v[32:35], v30 offset:4096
    ds_read_b128 v[36:39], v30 offset:5120
    v_smfmac_f32_16x16x64_bf16 v[100:103], v[44:47], v[184:191], v2
    ds_read_b128 v[40:43], v30 offset:6144
    v_smfmac_f32_16x16x64_bf16 v[104:107], v[44:47], v[248:255], v2
    ds_read_b128 v[44:47], v30 offset:7168
    s_waitcnt lgkmcnt(7)
    v_mfma_f32_16x16x32_bf16 v[80:83], v[64:67], v[48:51], 0
    ds_read_b128 v[64:67], v19 offset:0
    s_waitcnt lgkmcnt(7)
    v_mfma_f32_16x16x32_bf16 v[80:83], v[68:71], v[52:55], v[80:83]
    ds_read_b128 v[68:71], v19 offset:64
    s_mov_b64 exec, 0xffff
    buffer_load_dword v31, v24, s[8:11], s73 offen sc1
    s_mov_b64 exec, -1
    s_waitcnt lgkmcnt(7)
    v_mfma_f32_16x16x32_bf16 v[80:83], v[72:75], v[56:59], v[80:83]
    ds_read_b128 v[72:75], v19 offset:128
    s_waitcnt lgkmcnt(7)
    v_mfma_f32_16x16x32_bf16 v[80:83], v[76:79], v[60:63], v[80:83]
    ds_read_b128 v[76:79], v19 offset:192
    s_add_u32 s76, s76, 128
    s_waitcnt lgkmcnt(4)
    v_mfma_f32_16x16x32_bf16 v[84:87], v[32:35], v[48:51], 0
    buffer_store_dword v27, v16, s[8:11], s77 offen sc1
    v_add_f32 v100, v100, v102
    v_add_f32 v101, v101, v103
    v_mfma_f32_16x16x32_bf16 v[84:87], v[36:39], v[52:55], v[84:87]
    s_add_u32 s77, s77, 0x4000
    v_cvt_pk_bf16_f32 v122, v100, v101
    v_add_f32 v104, v104, v106
    v_mfma_f32_16x16x32_bf16 v[84:87], v[40:43], v[56:59], v[84:87]
    v_add_f32 v105, v105, v107
    v_cvt_pk_bf16_f32 v124, v104, v105
    v_mfma_f32_16x16x32_bf16 v[84:87], v[44:47], v[60:63], v[84:87]
    s_waitcnt lgkmcnt(0)
    v_mfma_f32_16x16x32_bf16 v[88:91], v[64:67], v[48:51], 0
    ds_read_b128 v[32:35], v22 offset:0
    v_max3_f32 v28, v80, v81, v82
    s_add_u32 s29, s29, 1
    v_mfma_f32_16x16x32_bf16 v[88:91], v[68:71], v[52:55], v[88:91]
    ds_read_b128 v[36:39], v22 offset:1024
    s_and_b32 s68, s29, 3
    s_lshl_b32 s68, s68, 14
    v_mfma_f32_16x16x32_bf16 v[88:91], v[72:75], v[56:59], v[88:91]
    ds_read_b128 v[40:43], v22 offset:16384
    s_add_u32 s68, s68, 0x8190000
    s_xor_b32 s80, s80, 0x2000
    v_mfma_f32_16x16x32_bf16 v[88:91], v[76:79], v[60:63], v[88:91]
    ds_read_b128 v[44:47], v22 offset:17408
    v_max3_f32 v28, v28, v83, v84
    v_max3_f32 v28, v28, v85, v86
    v_max_f32 v28, v28, v87
    v_mov_b64 v[104:105], 0
    v_mov_b64 v[106:107], 0
    v_mov_b32 v127, v121
    v_mov_b32 v127, v121
    v_max3_f32 v28, v28, v88, v89
    v_mov_b32 v29, v28
    ds_read_b128 v[48:51], v22 offset:8192
    ds_read_b128 v[52:55], v22 offset:9216
    v_permlane32_swap_b32 v28, v29
    v_max_f32 v28, v28, v29
    v_mov_b32 v29, v28
    ds_read_b128 v[56:59], v22 offset:24576
    ds_read_b128 v[60:63], v22 offset:25600
    v_permlane16_swap_b32 v28, v29
    v_max_f32 v28, v28, v29
    v_mul_f32 v28, 0xbe0293ee, v28
    v_pk_fma_f32 v[88:89], v[88:89], s[58:59], v[28:29] op_sel_hi:[1,0,0]
    v_pk_fma_f32 v[80:81], v[80:81], s[58:59], v[28:29] op_sel_hi:[1,0,0]
    v_pk_fma_f32 v[82:83], v[82:83], s[58:59], v[28:29] op_sel_hi:[1,0,0]
    v_pk_fma_f32 v[84:85], v[84:85], s[58:59], v[28:29] op_sel_hi:[1,0,0]
    v_pk_fma_f32 v[86:87], v[86:87], s[58:59], v[28:29] op_sel_hi:[1,0,0]
    v_exp_f32 v88, v88
    v_exp_f32 v89, v89
    v_exp_f32 v80, v80
    v_cvt_pk_bf16_f32 v120, v88, v89
    v_exp_f32 v81, v81
    v_exp_f32 v82, v82
    v_mfma_f32_16x16x16_bf16 v[100:103], v[8:9], v[120:121], 0
    v_exp_f32 v83, v83
    v_cvt_pk_bf16_f32 v116, v80, v81
    v_mfma_f32_16x16x16_bf16 v[92:95], v[122:123], v[120:121], 0
    v_exp_f32 v84, v84
    v_cvt_pk_bf16_f32 v117, v82, v83
    v_mfma_f32_16x16x16_bf16 v[96:99], v[124:125], v[120:121], 0
    v_exp_f32 v85, v85
    v_exp_f32 v86, v86
    v_exp_f32 v87, v87
    v_cvt_pk_bf16_f32 v118, v84, v85
    v_cvt_pk_bf16_f32 v119, v86, v87
    s_waitcnt vmcnt(5)
    v_mov_b64 v[88:89], 0
    ds_read_b128 v[64:67], v22 offset:32768
    v_mfma_f32_16x16x32_bf16 v[100:103], v[8:11], v[116:119], v[100:103]
    ds_read_b128 v[68:71], v22 offset:33792
    v_mov_b64 v[90:91], 0
    v_mov_b64 v[84:85], 0
    v_mfma_f32_16x16x32_bf16 v[92:95], v[108:111], v[116:119], v[92:95]
    ds_read_b128 v[72:75], v22 offset:49152
    v_mov_b64 v[86:87], 0
    v_mov_b64 v[80:81], 0
    v_mfma_f32_16x16x32_bf16 v[96:99], v[112:115], v[116:119], v[96:99]
    ds_read_b128 v[76:79], v22 offset:50176
    v_mov_b64 v[82:83], 0
    v_rcp_f32 v28, v100
    s_nop 4
    v_cndmask_b32 v92, v92, v96, s[60:61]
    v_cndmask_b32 v93, v93, v97, s[60:61]
    v_cndmask_b32 v94, v94, v98, s[60:61]
    v_cndmask_b32 v95, v95, v99, s[60:61]
    v_mul_f32 v92, v92, v28
    v_mul_f32 v93, v93, v28
    v_mul_f32 v94, v94, v28
    v_mul_f32 v95, v95, v28
    v_cvt_pk_bf16_f32 v116, v92, v93
    v_cvt_pk_bf16_f32 v117, v94, v95
    ds_write_b64 v20, v[116:117]
    v_mov_b64 v[100:101], 0
    s_nop 1
    v_mov_b64 v[102:103], 0
    s_nop 1
    v_mov_b64 v[92:93], 0
    s_nop 1
    s_waitcnt lgkmcnt(0)
    s_barrier
    ds_read_b128 v[108:111], v21 offset:29184
    ds_read_b128 v[112:115], v21 offset:30208
    v_mov_b64 v[116:117], 0
    v_mov_b64 v[118:119], 0
    v_mov_b64 v[94:95], 0
    v_mov_b64 v[96:97], 0
    v_mov_b64 v[98:99], 0
    s_waitcnt lgkmcnt(0)
    v_smfmac_f32_16x16x64_bf16 v[116:119], v[108:111], v[32:39], v2
    ds_read_b128 v[32:35], v22 offset:40960
    ds_read_b128 v[36:39], v22 offset:41984
    v_smfmac_f32_16x16x64_bf16 v[116:119], v[112:115], v[40:47], v2
    ds_read_b128 v[40:43], v22 offset:57344
    ds_read_b128 v[44:47], v22 offset:58368
    v_smfmac_f32_16x16x64_bf16 v[88:91], v[108:111], v[48:55], v2
    ds_read_b128 v[48:51], v23 offset:0
    ds_read_b128 v[52:55], v23 offset:1024
    v_smfmac_f32_16x16x64_bf16 v[88:91], v[112:115], v[56:63], v2
    ds_read_b128 v[56:59], v23 offset:16384
    ds_read_b128 v[60:63], v23 offset:17408
    v_add_f32 v116, v116, v118
    v_add_f32 v117, v117, v119
    v_cvt_pk_bf16_f32 v28, v116, v117
    v_bfi_b32 v28, v0, s50, v28
    v_smfmac_f32_16x16x64_bf16 v[84:87], v[108:111], v[64:71], v2
    buffer_store_dword v28, v13, s[8:11], s70 offen offset:0 sc1
    ds_read_b128 v[64:67], v23 offset:8192
    ds_read_b128 v[68:71], v23 offset:9216
    v_smfmac_f32_16x16x64_bf16 v[84:87], v[112:115], v[72:79], v2
    ds_read_b128 v[72:75], v23 offset:24576
    ds_read_b128 v[76:79], v23 offset:25600
    v_add_f32 v88, v88, v90
    v_add_f32 v89, v89, v91
    v_cvt_pk_bf16_f32 v29, v88, v89
    v_bfi_b32 v29, v0, s50, v29
    s_waitcnt lgkmcnt(8)
    v_smfmac_f32_16x16x64_bf16 v[104:107], v[108:111], v[32:39], v2
    buffer_store_dword v29, v13, s[8:11], s70 offen offset:256 sc1
    ds_read_b128 v[32:35], v23 offset:32768
    ds_read_b128 v[36:39], v23 offset:33792
    v_smfmac_f32_16x16x64_bf16 v[104:107], v[112:115], v[40:47], v2
    ds_read_b128 v[40:43], v23 offset:49152
    ds_read_b128 v[44:47], v23 offset:50176
    v_add_f32 v84, v84, v86
    v_add_f32 v85, v85, v87
    v_cvt_pk_bf16_f32 v28, v84, v85
    v_bfi_b32 v28, v0, s50, v28
    s_waitcnt lgkmcnt(8)
    v_smfmac_f32_16x16x64_bf16 v[80:83], v[108:111], v[48:55], v2
    buffer_store_dword v28, v13, s[8:11], s70 offen offset:512 sc1
    ds_read_b128 v[48:51], v23 offset:40960
    ds_read_b128 v[52:55], v23 offset:41984
    v_smfmac_f32_16x16x64_bf16 v[80:83], v[112:115], v[56:63], v2
    ds_read_b128 v[56:59], v23 offset:57344
    ds_read_b128 v[60:63], v23 offset:58368
    v_add_f32 v104, v104, v106
    v_add_f32 v105, v105, v107
    v_cvt_pk_bf16_f32 v29, v104, v105
    v_bfi_b32 v29, v0, s50, v29
    s_waitcnt lgkmcnt(8)
    v_smfmac_f32_16x16x64_bf16 v[100:103], v[108:111], v[64:71], v2
    buffer_store_dword v29, v13, s[8:11], s70 offen offset:768 sc1
    s_add_u32 s44, s68, s51
    v_smfmac_f32_16x16x64_bf16 v[100:103], v[112:115], v[72:79], v2
    s_add_u32 s45, s68, s42
    v_add_f32 v80, v80, v82
    v_add_f32 v81, v81, v83
    v_cvt_pk_bf16_f32 v28, v80, v81
    v_bfi_b32 v28, v0, s50, v28
    s_waitcnt lgkmcnt(4)
    v_smfmac_f32_16x16x64_bf16 v[92:95], v[108:111], v[32:39], v2
    buffer_store_dword v28, v13, s[8:11], s70 offen offset:1024 sc1
    v_smfmac_f32_16x16x64_bf16 v[92:95], v[112:115], v[40:47], v2
    ds_write2st64_b32 v3, v12, v12 offset0:0 offset1:4
    v_add_f32 v100, v100, v102
    v_add_f32 v101, v101, v103
    v_cvt_pk_bf16_f32 v29, v100, v101
    v_bfi_b32 v29, v0, s50, v29
    s_waitcnt lgkmcnt(1)
    v_smfmac_f32_16x16x64_bf16 v[96:99], v[108:111], v[48:55], v2
    buffer_store_dword v29, v13, s[8:11], s70 offen offset:1280 sc1
    v_smfmac_f32_16x16x64_bf16 v[96:99], v[112:115], v[56:63], v2
    v_add_f32 v92, v92, v94
    v_add_f32 v93, v93, v95
    v_cvt_pk_bf16_f32 v28, v92, v93
    v_bfi_b32 v28, v0, s50, v28
    buffer_store_dword v28, v13, s[8:11], s70 offen offset:1536 sc1
    s_mov_b32 m0, s69
    v_mov_b64 v[84:85], 0
    v_mov_b64 v[86:87], 0
    v_add_f32 v96, v96, v98
    v_add_f32 v97, v97, v99
    v_cvt_pk_bf16_f32 v29, v96, v97
    v_bfi_b32 v29, v0, s50, v29
    buffer_store_dword v29, v13, s[8:11], s70 offen offset:1792 sc1
    s_waitcnt lgkmcnt(0)
    s_barrier
    s_cmp_lt_u32 s64, 2
    s_cbranch_scc1 L_nored_f
    s_mov_b32 s40, s63
    s_sub_u32 s40, s40, 1
    s_cbranch_scc1 L_gath_f
    s_nop 1
    s_sub_u32 s40, s40, 1
    s_cbranch_scc1 L_gath_f
    s_nop 1
    s_sub_u32 s40, s40, 1
    s_cbranch_scc1 L_gath_f
    s_nop 1
    s_sub_u32 s40, s40, 1
    s_cbranch_scc1 L_gath_f
    s_nop 1
    s_sub_u32 s40, s40, 1
    s_cbranch_scc1 L_gath_f
    s_nop 1
    s_sub_u32 s40, s40, 1
    s_cbranch_scc1 L_gath_f
    s_nop 1
    s_sub_u32 s40, s40, 1
    s_cbranch_scc1 L_gath_f
    s_nop 1
    s_sub_u32 s40, s40, 1
    s_cbranch_scc1 L_gath_f
    s_nop 1
    s_sub_u32 s40, s40, 1
    s_cbranch_scc1 L_gath_f
    s_nop 1
    s_sub_u32 s40, s40, 1
    s_cbranch_scc1 L_gath_f
    s_nop 1
    s_sub_u32 s40, s40, 1
    s_cbranch_scc1 L_gath_f
    s_nop 1
    s_sub_u32 s40, s40, 1
    s_cbranch_scc1 L_gath_f
    s_nop 1
    s_sub_u32 s40, s40, 1
    s_cbranch_scc1 L_gath_f
    s_nop 1
    s_sub_u32 s40, s40, 1
    s_cbranch_scc1 L_gath_f
    s_nop 1
    s_sub_u32 s40, s40, 1
    s_cbranch_scc1 L_gath_f
    s_nop 1
    s_sub_u32 s40, s40, 1
    s_cbranch_scc1 L_gath_f
    s_nop 1
    s_sub_u32 s40, s40, 1
    s_cbranch_scc1 L_gath_f
    s_nop 1
    s_sub_u32 s40, s40, 1
    s_cbranch_scc1 L_gath_f
    s_nop 1
    s_sub_u32 s40, s40, 1
    s_cbranch_scc1 L_gath_f
    s_nop 1
    s_sub_u32 s40, s40, 1
    s_cbranch_scc1 L_gath_f
    s_nop 1
    s_sub_u32 s40, s40, 1
    s_cbranch_scc1 L_gath_f
    s_nop 1
    s_sub_u32 s40, s40, 1
    s_cbranch_scc1 L_gath_f
    s_nop 1
    s_sub_u32 s40, s40, 1
    s_cbranch_scc1 L_gath_f
    s_nop 1
    s_sub_u32 s40, s40, 1
    s_cbranch_scc1 L_gath_f
    s_nop 1
L_gath_f:
    buffer_load_dwordx4 v[64:67], v14, s[8:11], s70 offen sc1
    buffer_load_dwordx4 v[68:71], v14, s[8:11], s71 offen sc1
    buffer_load_dwordx4 v[72:75], v14, s[8:11], s72 offen sc1
    buffer_load_dwordx4 v[76:79], v14, s[8:11], s62 offen sc1
    v_mov_b64 v[104:105], 0
    v_mov_b64 v[106:107], 0
    v_mov_b64 v[80:81], 0
    v_mov_b64 v[82:83], 0
    v_mov_b64 v[100:101], 0
    v_mov_b64 v[102:103], 0
    v_mov_b64 v[92:93], 0
    v_mov_b64 v[94:95], 0
    v_mov_b64 v[96:97], 0
    v_mov_b64 v[98:99], 0
L_chk_f:
    s_waitcnt vmcnt(3)
    v_mfma_f32_16x16x32_bf16 v[32:35], v[4:7], v[64:67], 0
    v_and_b32 v28, 1, v64
    v_cmp_ne_u32 s[46:47], s50, v28
    s_waitcnt vmcnt(2)
    v_mfma_f32_16x16x32_bf16 v[32:35], v[4:7], v[68:71], v[32:35]
    v_and_b32 v28, 1, v68
    v_cmp_ne_u32 s[48:49], s50, v28
    s_waitcnt vmcnt(1)
    v_mfma_f32_16x16x32_bf16 v[32:35], v[4:7], v[72:75], v[32:35]
    v_and_b32 v28, 1, v72
    v_cmp_ne_u32 s[4:5], s50, v28
    s_waitcnt vmcnt(0)
    v_mfma_f32_16x16x32_bf16 v[32:35], v[4:7], v[76:79], v[32:35]
    v_and_b32 v28, 1, v76
    v_cmp_ne_u32 s[6:7], s50, v28
    s_or_b64 vcc, s[46:47], s[48:49]
    s_or_b64 vcc, vcc, s[4:5]
    s_or_b64 vcc, vcc, s[6:7]
    s_cbranch_scc1 L_redb_f
    s_nop 1
    v_add_f32_dpp v32, v32, v32 row_ror:8 row_mask:0xf bank_mask:0xf
    v_add_f32_dpp v33, v33, v33 row_ror:8 row_mask:0xf bank_mask:0xf
    v_cvt_pk_bf16_f32 v27, v32, v33
    buffer_store_dword v27, v16, s[8:11], s68 offen sc1
    s_add_u32 s78, s29, 3
    s_and_b32 s78, s78, 3
    s_lshl_b32 s78, s78, 14
    s_add_u32 s78, s78, 0x8190000
    s_bfe_u32 s50, s29, 0x10001
    s_xor_b32 s70, s70, 294912
    s_xor_b32 s71, s71, 294912
    s_xor_b32 s72, s72, 360448
    s_xor_b32 s62, s62, 360448
    s_mov_b64 s[46:47], -1
    s_mov_b64 s[48:49], -1
    s_cmp_lt_u32 s29, 63
    s_cbranch_scc1 L_step_f
    s_branch L_fin_f
L_nored_f:
    v_mov_b64 v[104:105], 0
    v_mov_b64 v[106:107], 0
    v_mov_b64 v[80:81], 0
    v_mov_b64 v[82:83], 0
    v_mov_b64 v[100:101], 0
    v_mov_b64 v[102:103], 0
    v_mov_b64 v[92:93], 0
    v_mov_b64 v[94:95], 0
    v_mov_b64 v[96:97], 0
    v_mov_b64 v[98:99], 0
    s_add_u32 s78, s29, 3
    s_and_b32 s78, s78, 3
    s_lshl_b32 s78, s78, 14
    s_add_u32 s78, s78, 0x8190000
    s_bfe_u32 s50, s29, 0x10001
    s_xor_b32 s70, s70, 294912
    s_xor_b32 s71, s71, 294912
    s_xor_b32 s72, s72, 360448
    s_xor_b32 s62, s62, 360448
    s_mov_b64 s[46:47], -1
    s_mov_b64 s[48:49], -1
    s_cmp_lt_u32 s29, 63
    s_cbranch_scc1 L_step_f
L_fin_f:
    buffer_store_dword v27, v16, s[8:11], s77 offen sc1
    s_endpgm
L_rty2_f:
    ds_read_b128 v[48:51], v21 offset:17408
    ds_read2st64_b32 v[28:29], v3 offset0:0 offset1:4
L_rtl2_f:
    ds_read_b128 v[40:43], v21 offset:17408
    v_mov_b32 v127, v121
    s_waitcnt lgkmcnt(1)
    v_cmp_eq_u32 vcc, -1, v48
    v_cmp_eq_u32 s[46:47], -1, v28
    v_cmp_eq_u32 s[48:49], -1, v29
    s_mov_b64 exec, s[46:47]
    buffer_load_dwordx4 v25, s[8:11], s44 offen sc1 lds
    s_mov_b64 exec, s[48:49]
    buffer_load_dwordx4 v25, s[8:11], s45 offen offset:1024 sc1 lds
    s_mov_b64 exec, -1
    s_cbranch_vccz L_rtx2_f
    ds_read_b128 v[48:51], v21 offset:17408
    ds_read2st64_b32 v[28:29], v3 offset0:0 offset1:4
    s_sub_u32 s28, s28, 1
    s_cbranch_scc1 L_fail
    s_waitcnt lgkmcnt(2)
    v_cmp_eq_u32 vcc, -1, v40
    s_nop 1
    v_mov_b32 v127, v121
    s_nop 1
    v_mov_b32 v127, v121
    s_cbranch_vccnz L_rtl2_f
L_rtx2_f:
    s_waitcnt lgkmcnt(0)
    s_branch L_go2_f
L_rty3_f:
    ds_read_b128 v[48:51], v21 offset:19456
    ds_read2st64_b32 v[28:29], v3 offset0:0 offset1:4
L_rtl3_f:
    ds_read_b128 v[44:47], v21 offset:19456
    v_mov_b32 v127, v121
    s_waitcnt lgkmcnt(1)
    v_cmp_eq_u32 vcc, -1, v48
    v_cmp_eq_u32 s[46:47], -1, v28
    v_cmp_eq_u32 s[48:49], -1, v29
    s_mov_b64 exec, s[46:47]
    buffer_load_dwordx4 v25, s[8:11], s44 offen sc1 lds
    s_mov_b64 exec, s[48:49]
    buffer_load_dwordx4 v25, s[8:11], s45 offen offset:1024 sc1 lds
    s_mov_b64 exec, -1
    s_cbranch_vccz L_rtx3_f
    ds_read_b128 v[48:51], v21 offset:19456
    ds_read2st64_b32 v[28:29], v3 offset0:0 offset1:4
    s_sub_u32 s28, s28, 1
    s_cbranch_scc1 L_fail
    s_waitcnt lgkmcnt(2)
    v_cmp_eq_u32 vcc, -1, v44
    s_nop 1
    v_mov_b32 v127, v121
    s_nop 1
    v_mov_b32 v127, v121
    s_cbranch_vccnz L_rtl3_f
L_rtx3_f:
    s_waitcnt lgkmcnt(0)
    s_branch L_go3_f
L_rty4_f:
    ds_read_b128 v[48:51], v21 offset:20480
    ds_read2st64_b32 v[28:29], v3 offset0:0 offset1:4
L_rtl4_f:
    ds_read_b128 v[32:35], v21 offset:20480
    v_mov_b32 v127, v121
    s_waitcnt lgkmcnt(1)
    v_cmp_eq_u32 vcc, -1, v48
    v_cmp_eq_u32 s[46:47], -1, v28
    v_cmp_eq_u32 s[48:49], -1, v29
    s_mov_b64 exec, s[46:47]
    buffer_load_dwordx4 v25, s[8:11], s44 offen sc1 lds
    s_mov_b64 exec, s[48:49]
    buffer_load_dwordx4 v25, s[8:11], s45 offen offset:1024 sc1 lds
    s_mov_b64 exec, -1
    s_cbranch_vccz L_rtx4_f
    ds_read_b128 v[48:51], v21 offset:20480
    ds_read2st64_b32 v[28:29], v3 offset0:0 offset1:4
    s_sub_u32 s28, s28, 1
    s_cbranch_scc1 L_fail
    s_waitcnt lgkmcnt(2)
    v_cmp_eq_u32 vcc, -1, v32
    s_nop 1
    v_mov_b32 v127, v121
    s_nop 1
    v_mov_b32 v127, v121
    s_cbranch_vccnz L_rtl4_f
L_rtx4_f:
    s_waitcnt lgkmcnt(0)
    s_branch L_go4_f
L_rty5_f:
    ds_read_b128 v[48:51], v21 offset:22528
    ds_read2st64_b32 v[28:29], v3 offset0:0 offset1:4
L_rtl5_f:
    ds_read_b128 v[36:39], v21 offset:22528
    v_mov_b32 v127, v121
    s_waitcnt lgkmcnt(1)
    v_cmp_eq_u32 vcc, -1, v48
    v_cmp_eq_u32 s[46:47], -1, v28
    v_cmp_eq_u32 s[48:49], -1, v29
    s_mov_b64 exec, s[46:47]
    buffer_load_dwordx4 v25, s[8:11], s44 offen sc1 lds
    s_mov_b64 exec, s[48:49]
    buffer_load_dwordx4 v25, s[8:11], s45 offen offset:1024 sc1 lds
    s_mov_b64 exec, -1
    s_cbranch_vccz L_rtx5_f
    ds_read_b128 v[48:51], v21 offset:22528
    ds_read2st64_b32 v[28:29], v3 offset0:0 offset1:4
    s_sub_u32 s28, s28, 1
    s_cbranch_scc1 L_fail
    s_waitcnt lgkmcnt(2)
    v_cmp_eq_u32 vcc, -1, v36
    s_nop 1
    v_mov_b32 v127, v121
    s_nop 1
    v_mov_b32 v127, v121
    s_cbranch_vccnz L_rtl5_f
L_rtx5_f:
    s_waitcnt lgkmcnt(0)
    s_branch L_go5_f
L_rty6_f:
    ds_read_b128 v[48:51], v21 offset:21504
    ds_read2st64_b32 v[28:29], v3 offset0:0 offset1:4
L_rtl6_f:
    ds_read_b128 v[40:43], v21 offset:21504
    v_mov_b32 v127, v121
    s_waitcnt lgkmcnt(1)
    v_cmp_eq_u32 vcc, -1, v48
    v_cmp_eq_u32 s[46:47], -1, v28
    v_cmp_eq_u32 s[48:49], -1, v29
    s_mov_b64 exec, s[46:47]
    buffer_load_dwordx4 v25, s[8:11], s44 offen sc1 lds
    s_mov_b64 exec, s[48:49]
    buffer_load_dwordx4 v25, s[8:11], s45 offen offset:1024 sc1 lds
    s_mov_b64 exec, -1
    s_cbranch_vccz L_rtx6_f
    ds_read_b128 v[48:51], v21 offset:21504
    ds_read2st64_b32 v[28:29], v3 offset0:0 offset1:4
    s_sub_u32 s28, s28, 1
    s_cbranch_scc1 L_fail
    s_waitcnt lgkmcnt(2)
    v_cmp_eq_u32 vcc, -1, v40
    s_nop 1
    v_mov_b32 v127, v121
    s_nop 1
    v_mov_b32 v127, v121
    s_cbranch_vccnz L_rtl6_f
L_rtx6_f:
    s_waitcnt lgkmcnt(0)
    s_branch L_go6_f
L_rty7_f:
    ds_read_b128 v[48:51], v21 offset:23552
    ds_read2st64_b32 v[28:29], v3 offset0:0 offset1:4
L_rtl7_f:
    ds_read_b128 v[44:47], v21 offset:23552
    v_mov_b32 v127, v121
    s_waitcnt lgkmcnt(1)
    v_cmp_eq_u32 vcc, -1, v48
    v_cmp_eq_u32 s[46:47], -1, v28
    v_cmp_eq_u32 s[48:49], -1, v29
    s_mov_b64 exec, s[46:47]
    buffer_load_dwordx4 v25, s[8:11], s44 offen sc1 lds
    s_mov_b64 exec, s[48:49]
    buffer_load_dwordx4 v25, s[8:11], s45 offen offset:1024 sc1 lds
    s_mov_b64 exec, -1
    s_cbranch_vccz L_rtx7_f
    ds_read_b128 v[48:51], v21 offset:23552
    ds_read2st64_b32 v[28:29], v3 offset0:0 offset1:4
    s_sub_u32 s28, s28, 1
    s_cbranch_scc1 L_fail
    s_waitcnt lgkmcnt(2)
    v_cmp_eq_u32 vcc, -1, v44
    s_nop 1
    v_mov_b32 v127, v121
    s_nop 1
    v_mov_b32 v127, v121
    s_cbranch_vccnz L_rtl7_f
L_rtx7_f:
    s_waitcnt lgkmcnt(0)
    s_branch L_go7_f
L_flgw_f:
    s_sub_u32 s28, s28, 1
    s_cbranch_scc1 L_fail
    s_sleep 1
    buffer_load_dword v26, v121, s[8:11], s76 offen offset:128 sc1
    s_waitcnt vmcnt(0)
    v_cmp_eq_u32 vcc, -1, v26
    s_cbranch_vccnz L_flgw_f
    s_branch L_flg_f
L_redb_f:
    s_mov_b64 exec, s[46:47]
    buffer_load_dwordx4 v[64:67], v14, s[8:11], s70 offen sc1
    s_mov_b64 exec, s[48:49]
    buffer_load_dwordx4 v[68:71], v14, s[8:11], s71 offen sc1
    s_mov_b64 exec, s[4:5]
    buffer_load_dwordx4 v[72:75], v14, s[8:11], s72 offen sc1
    s_mov_b64 exec, s[6:7]
    buffer_load_dwordx4 v[76:79], v14, s[8:11], s62 offen sc1
    s_mov_b64 exec, -1
    s_sub_u32 s28, s28, 1
    s_cbranch_scc1 L_fail
    s_branch L_chk_f
L_worker:
    s_min_u32 s4, s65, 12
    s_mul_i32 s30, s65, 5
    s_add_u32 s30, s30, s4
    s_cmp_lt_u32 s65, 12
    s_cselect_b32 s31, 6, 5
    v_lshrrev_b32 v50, 3, v3
    v_bfe_u32 v51, v3, 1, 2
    v_bfe_u32 v52, v3, 4, 1
    v_xor_b32 v51, v51, v52
    v_and_b32 v53, 1, v3
    v_mul_u32_u24 v50, 2752, v50
    s_lshl_b32 s4, s30, 4
    v_add_u32 v50, s4, v50
    v_mov_b32 v54, 0x80000000
    v_xor_b32 v55, 0, v51
    v_lshl_or_b32 v55, v55, 1, v53
    v_cmp_gt_u32 vcc, s31, v55
    v_lshl_add_u32 v55, v55, 4, v50
    s_nop 0
    v_cndmask_b32 v60, v54, v55, vcc
    v_xor_b32 v55, 2, v51
    v_lshl_or_b32 v55, v55, 1, v53
    v_cmp_gt_u32 vcc, s31, v55
    v_lshl_add_u32 v55, v55, 4, v50
    s_nop 0
    v_cndmask_b32 v61, v54, v55, vcc
    s_lshl_b32 s4, s64, 6
    v_xor_b32 v20, s4, v1
    v_xor_b32 v21, 16, v20
    v_xor_b32 v22, 32, v20
    v_xor_b32 v23, 48, v20
    s_mul_i32 s100, s64, 88064
    s_mov_b32 s29, s66
    s_mov_b32 s16, s56
    s_and_b32 s17, s57, 0xffff
    s_mov_b32 s18, 0x400
    s_mov_b32 s19, 0x20000
    v_lshlrev_b32 v50, 1, v0
    buffer_load_ushort v62, v50, s[16:19], 0 offen
    buffer_load_ushort v63, v50, s[16:19], 0 offen offset:512
    s_mov_b32 s16, s50
    s_and_b32 s17, s51, 0xffff
    s_mov_b32 s18, 0xac0
    s_mov_b32 s19, 0x20000
    v_lshrrev_b32 v50, 4, v3
    s_lshl_b32 s4, s64, 2
    v_add_u32 v50, s4, v50
    s_lshl_b32 s5, s31, 1
    v_cmp_gt_u32 vcc, s5, v50
    v_lshlrev_b32 v50, 3, v50
    s_lshl_b32 s4, s30, 4
    v_add_u32 v50, s4, v50
    v_cndmask_b32 v50, v54, v50, vcc
    buffer_load_dwordx2 v[64:65], v50, s[16:19], 0 offen
    s_add_u32 s92, s99, 0x0
    s_add_u32 s93, s98, 0x0
    s_mov_b32 m0, s93
    s_nop 0
    buffer_load_dwordx4 v32, s[72:75], s92 offen lds
    s_add_u32 s92, s99, 0x8000
    s_add_u32 s93, s98, 0x400
    s_mov_b32 m0, s93
    s_nop 0
    buffer_load_dwordx4 v32, s[72:75], s92 offen lds
    s_add_u32 s92, s99, 0x10000
    s_add_u32 s93, s98, 0x800
    s_mov_b32 m0, s93
    s_nop 0
    buffer_load_dwordx4 v33, s[72:75], s92 offen lds
    s_add_u32 s92, s99, 0x18000
    s_add_u32 s93, s98, 0xc00
    s_mov_b32 m0, s93
    s_nop 0
    buffer_load_dwordx4 v33, s[72:75], s92 offen lds
    s_add_u32 s92, s99, 0x80000
    s_add_u32 s93, s98, 0x4000
    s_mov_b32 m0, s93
    s_nop 0
    buffer_load_dwordx4 v32, s[72:75], s92 offen lds
    s_add_u32 s92, s99, 0x88000
    s_add_u32 s93, s98, 0x4400
    s_mov_b32 m0, s93
    s_nop 0
    buffer_load_dwordx4 v32, s[72:75], s92 offen lds
    s_add_u32 s92, s99, 0x90000
    s_add_u32 s93, s98, 0x4800
    s_mov_b32 m0, s93
    s_nop 0
    buffer_load_dwordx4 v33, s[72:75], s92 offen lds
    s_add_u32 s92, s99, 0x98000
    s_add_u32 s93, s98, 0x4c00
    s_mov_b32 m0, s93
    s_nop 0
    buffer_load_dwordx4 v33, s[72:75], s92 offen lds
    s_add_u32 s92, s99, 0x100000
    s_add_u32 s93, s98, 0x8000
    s_mov_b32 m0, s93
    s_nop 0
    buffer_load_dwordx4 v32, s[72:75], s92 offen lds
    s_add_u32 s92, s99, 0x108000
    s_add_u32 s93, s98, 0x8400
    s_mov_b32 m0, s93
    s_nop 0
    buffer_load_dwordx4 v32, s[72:75], s92 offen lds
    s_add_u32 s92, s99, 0x110000
    s_add_u32 s93, s98, 0x8800
    s_mov_b32 m0, s93
    s_nop 0
    buffer_load_dwordx4 v33, s[72:75], s92 offen lds
    s_add_u32 s92, s99, 0x118000
    s_add_u32 s93, s98, 0x8c00
    s_mov_b32 m0, s93
    s_nop 0
    buffer_load_dwordx4 v33, s[72:75], s92 offen lds
    s_add_u32 s92, s99, 0x180000
    s_add_u32 s93, s98, 0xc000
    s_mov_b32 m0, s93
    s_nop 0
    buffer_load_dwordx4 v32, s[72:75], s92 offen lds
    s_add_u32 s92, s99, 0x188000
    s_add_u32 s93, s98, 0xc400
    s_mov_b32 m0, s93
    s_nop 0
    buffer_load_dwordx4 v32, s[72:75], s92 offen lds
    s_add_u32 s92, s99, 0x190000
    s_add_u32 s93, s98, 0xc800
    s_mov_b32 m0, s93
    s_nop 0
    buffer_load_dwordx4 v33, s[72:75], s92 offen lds
    s_add_u32 s92, s99, 0x198000
    s_add_u32 s93, s98, 0xcc00
    s_mov_b32 m0, s93
    s_nop 0
    buffer_load_dwordx4 v33, s[72:75], s92 offen lds
    s_add_u32 s92, s99, 0x200000
    s_add_u32 s93, s98, 0x10000
    s_mov_b32 m0, s93
    s_nop 0
    buffer_load_dwordx4 v32, s[72:75], s92 offen lds
    s_add_u32 s92, s99, 0x208000
    s_add_u32 s93, s98, 0x10400
    s_mov_b32 m0, s93
    s_nop 0
    buffer_load_dwordx4 v32, s[72:75], s92 offen lds
    s_add_u32 s92, s99, 0x210000
    s_add_u32 s93, s98, 0x10800
    s_mov_b32 m0, s93
    s_nop 0
    buffer_load_dwordx4 v33, s[72:75], s92 offen lds
    s_add_u32 s92, s99, 0x218000
    s_add_u32 s93, s98, 0x10c00
    s_mov_b32 m0, s93
    s_nop 0
    buffer_load_dwordx4 v33, s[72:75], s92 offen lds
    s_add_u32 s92, s99, 0x280000
    s_add_u32 s93, s98, 0x14000
    s_mov_b32 m0, s93
    s_nop 0
    buffer_load_dwordx4 v32, s[72:75], s92 offen lds
    s_add_u32 s92, s99, 0x288000
    s_add_u32 s93, s98, 0x14400
    s_mov_b32 m0, s93
    s_nop 0
    buffer_load_dwordx4 v32, s[72:75], s92 offen lds
    s_add_u32 s92, s99, 0x290000
    s_add_u32 s93, s98, 0x14800
    s_mov_b32 m0, s93
    s_nop 0
    buffer_load_dwordx4 v33, s[72:75], s92 offen lds
    s_add_u32 s92, s99, 0x298000
    s_add_u32 s93, s98, 0x14c00
    s_mov_b32 m0, s93
    s_nop 0
    buffer_load_dwordx4 v33, s[72:75], s92 offen lds
    s_add_u32 s92, s99, 0x300000
    s_add_u32 s93, s98, 0x18000
    s_mov_b32 m0, s93
    s_nop 0
    buffer_load_dwordx4 v32, s[72:75], s92 offen lds
    s_add_u32 s92, s99, 0x308000
    s_add_u32 s93, s98, 0x18400
    s_mov_b32 m0, s93
    s_nop 0
    buffer_load_dwordx4 v32, s[72:75], s92 offen lds
    s_add_u32 s92, s99, 0x310000
    s_add_u32 s93, s98, 0x18800
    s_mov_b32 m0, s93
    s_nop 0
    buffer_load_dwordx4 v33, s[72:75], s92 offen lds
    s_add_u32 s92, s99, 0x318000
    s_add_u32 s93, s98, 0x18c00
    s_mov_b32 m0, s93
    s_nop 0
    buffer_load_dwordx4 v33, s[72:75], s92 offen lds
    s_add_u32 s16, s62, 0x8000000
    s_addc_u32 s17, s63, 0
    s_and_b32 s17, s17, 0xffff
    s_mov_b32 s18, 0x1a6400
    s_mov_b32 s19, 0x20000
    s_mov_b32 s5, 0x100000
    buffer_store_dwordx4 v[12:15], v30, s[16:19], 0 offen sc1
    buffer_store_dwordx4 v[12:15], v30, s[16:19], s5 offen sc1
    s_waitcnt vmcnt(26)
    s_barrier
    s_add_u32 s92, s99, 0x380000
    s_add_u32 s93, s98, 0x1c000
    s_mov_b32 m0, s93
    s_nop 0
    buffer_load_dwordx4 v32, s[72:75], s92 offen lds
    s_add_u32 s92, s99, 0x388000
    s_add_u32 s93, s98, 0x1c400
    s_mov_b32 m0, s93
    s_nop 0
    buffer_load_dwordx4 v32, s[72:75], s92 offen lds
    s_add_u32 s92, s99, 0x390000
    s_add_u32 s93, s98, 0x1c800
    s_mov_b32 m0, s93
    s_nop 0
    buffer_load_dwordx4 v33, s[72:75], s92 offen lds
    s_add_u32 s92, s99, 0x398000
    s_add_u32 s93, s98, 0x1cc00
    s_mov_b32 m0, s93
    s_nop 0
    buffer_load_dwordx4 v33, s[72:75], s92 offen lds
    ds_read_b64_tr_b16 a[128:129], v36 offset:0
    ds_read_b64_tr_b16 a[130:131], v36 offset:1024
    ds_read_b64_tr_b16 a[132:133], v36 offset:8192
    ds_read_b64_tr_b16 a[134:135], v36 offset:9216
    ds_read_b64_tr_b16 a[192:193], v37 offset:0
    ds_read_b64_tr_b16 a[194:195], v37 offset:1024
    ds_read_b64_tr_b16 a[196:197], v37 offset:8192
    ds_read_b64_tr_b16 a[198:199], v37 offset:9216
    s_waitcnt lgkmcnt(0)
    s_waitcnt vmcnt(26)
    s_barrier
    s_add_u32 s92, s99, 0x0
    s_add_u32 s93, s98, 0x0
    s_mov_b32 m0, s93
    s_nop 0
    buffer_load_dwordx4 v32, s[76:79], s92 offen lds
    s_add_u32 s92, s99, 0x8000
    s_add_u32 s93, s98, 0x400
    s_mov_b32 m0, s93
    s_nop 0
    buffer_load_dwordx4 v32, s[76:79], s92 offen lds
    s_add_u32 s92, s99, 0x10000
    s_add_u32 s93, s98, 0x800
    s_mov_b32 m0, s93
    s_nop 0
    buffer_load_dwordx4 v33, s[76:79], s92 offen lds
    s_add_u32 s92, s99, 0x18000
    s_add_u32 s93, s98, 0xc00
    s_mov_b32 m0, s93
    s_nop 0
    buffer_load_dwordx4 v33, s[76:79], s92 offen lds
    ds_read_b64_tr_b16 a[136:137], v36 offset:16384
    ds_read_b64_tr_b16 a[138:139], v36 offset:17408
    ds_read_b64_tr_b16 a[140:141], v36 offset:24576
    ds_read_b64_tr_b16 a[142:143], v36 offset:25600
    ds_read_b64_tr_b16 a[200:201], v37 offset:16384
    ds_read_b64_tr_b16 a[202:203], v37 offset:17408
    ds_read_b64_tr_b16 a[204:205], v37 offset:24576
    ds_read_b64_tr_b16 a[206:207], v37 offset:25600
    s_waitcnt lgkmcnt(0)
    s_waitcnt vmcnt(26)
    s_barrier
    s_add_u32 s92, s99, 0x80000
    s_add_u32 s93, s98, 0x4000
    s_mov_b32 m0, s93
    s_nop 0
    buffer_load_dwordx4 v32, s[76:79], s92 offen lds
    s_add_u32 s92, s99, 0x88000
    s_add_u32 s93, s98, 0x4400
    s_mov_b32 m0, s93
    s_nop 0
    buffer_load_dwordx4 v32, s[76:79], s92 offen lds
    s_add_u32 s92, s99, 0x90000
    s_add_u32 s93, s98, 0x4800
    s_mov_b32 m0, s93
    s_nop 0
    buffer_load_dwordx4 v33, s[76:79], s92 offen lds
    s_add_u32 s92, s99, 0x98000
    s_add_u32 s93, s98, 0x4c00
    s_mov_b32 m0, s93
    s_nop 0
    buffer_load_dwordx4 v33, s[76:79], s92 offen lds
    ds_read_b64_tr_b16 a[144:145], v36 offset:32768
    ds_read_b64_tr_b16 a[146:147], v36 offset:33792
    ds_read_b64_tr_b16 a[148:149], v36 offset:40960
    ds_read_b64_tr_b16 a[150:151], v36 offset:41984
    ds_read_b64_tr_b16 a[208:209], v37 offset:32768
    ds_read_b64_tr_b16 a[210:211], v37 offset:33792
    ds_read_b64_tr_b16 a[212:213], v37 offset:40960
    ds_read_b64_tr_b16 a[214:215], v37 offset:41984
    s_waitcnt lgkmcnt(0)
    s_waitcnt vmcnt(26)
    s_barrier
    s_add_u32 s92, s99, 0x100000
    s_add_u32 s93, s98, 0x8000
    s_mov_b32 m0, s93
    s_nop 0
    buffer_load_dwordx4 v32, s[76:79], s92 offen lds
    s_add_u32 s92, s99, 0x108000
    s_add_u32 s93, s98, 0x8400
    s_mov_b32 m0, s93
    s_nop 0
    buffer_load_dwordx4 v32, s[76:79], s92 offen lds
    s_add_u32 s92, s99, 0x110000
    s_add_u32 s93, s98, 0x8800
    s_mov_b32 m0, s93
    s_nop 0
    buffer_load_dwordx4 v33, s[76:79], s92 offen lds
    s_add_u32 s92, s99, 0x118000
    s_add_u32 s93, s98, 0x8c00
    s_mov_b32 m0, s93
    s_nop 0
    buffer_load_dwordx4 v33, s[76:79], s92 offen lds
    ds_read_b64_tr_b16 a[152:153], v36 offset:49152
    ds_read_b64_tr_b16 a[154:155], v36 offset:50176
    ds_read_b64_tr_b16 a[156:157], v36 offset:57344
    ds_read_b64_tr_b16 a[158:159], v36 offset:58368
    ds_read_b64_tr_b16 a[216:217], v37 offset:49152
    ds_read_b64_tr_b16 a[218:219], v37 offset:50176
    ds_read_b64_tr_b16 a[220:221], v37 offset:57344
    ds_read_b64_tr_b16 a[222:223], v37 offset:58368
    s_waitcnt lgkmcnt(0)
    s_waitcnt vmcnt(26)
    s_barrier
    s_add_u32 s92, s99, 0x180000
    s_add_u32 s93, s98, 0xc000
    s_mov_b32 m0, s93
    s_nop 0
    buffer_load_dwordx4 v32, s[76:79], s92 offen lds
    s_add_u32 s92, s99, 0x188000
    s_add_u32 s93, s98, 0xc400
    s_mov_b32 m0, s93
    s_nop 0
    buffer_load_dwordx4 v32, s[76:79], s92 offen lds
    s_add_u32 s92, s99, 0x190000
    s_add_u32 s93, s98, 0xc800
    s_mov_b32 m0, s93
    s_nop 0
    buffer_load_dwordx4 v33, s[76:79], s92 offen lds
    s_add_u32 s92, s99, 0x198000
    s_add_u32 s93, s98, 0xcc00
    s_mov_b32 m0, s93
    s_nop 0
    buffer_load_dwordx4 v33, s[76:79], s92 offen lds
    ds_read_b64_tr_b16 a[160:161], v38 offset:0
    ds_read_b64_tr_b16 a[162:163], v38 offset:1024
    ds_read_b64_tr_b16 a[164:165], v38 offset:8192
    ds_read_b64_tr_b16 a[166:167], v38 offset:9216
    ds_read_b64_tr_b16 a[224:225], v39 offset:0
    ds_read_b64_tr_b16 a[226:227], v39 offset:1024
    ds_read_b64_tr_b16 a[228:229], v39 offset:8192
    ds_read_b64_tr_b16 a[230:231], v39 offset:9216
    s_waitcnt lgkmcnt(0)
    s_waitcnt vmcnt(26)
    s_barrier
    s_add_u32 s92, s99, 0x200000
    s_add_u32 s93, s98, 0x10000
    s_mov_b32 m0, s93
    s_nop 0
    buffer_load_dwordx4 v32, s[76:79], s92 offen lds
    s_add_u32 s92, s99, 0x208000
    s_add_u32 s93, s98, 0x10400
    s_mov_b32 m0, s93
    s_nop 0
    buffer_load_dwordx4 v32, s[76:79], s92 offen lds
    s_add_u32 s92, s99, 0x210000
    s_add_u32 s93, s98, 0x10800
    s_mov_b32 m0, s93
    s_nop 0
    buffer_load_dwordx4 v33, s[76:79], s92 offen lds
    s_add_u32 s92, s99, 0x218000
    s_add_u32 s93, s98, 0x10c00
    s_mov_b32 m0, s93
    s_nop 0
    buffer_load_dwordx4 v33, s[76:79], s92 offen lds
    ds_read_b64_tr_b16 a[168:169], v38 offset:16384
    ds_read_b64_tr_b16 a[170:171], v38 offset:17408
    ds_read_b64_tr_b16 a[172:173], v38 offset:24576
    ds_read_b64_tr_b16 a[174:175], v38 offset:25600
    ds_read_b64_tr_b16 a[232:233], v39 offset:16384
    ds_read_b64_tr_b16 a[234:235], v39 offset:17408
    ds_read_b64_tr_b16 a[236:237], v39 offset:24576
    ds_read_b64_tr_b16 a[238:239], v39 offset:25600
    s_waitcnt lgkmcnt(0)
    s_waitcnt vmcnt(26)
    s_barrier
    s_add_u32 s92, s99, 0x280000
    s_add_u32 s93, s98, 0x14000
    s_mov_b32 m0, s93
    s_nop 0
    buffer_load_dwordx4 v32, s[76:79], s92 offen lds
    s_add_u32 s92, s99, 0x288000
    s_add_u32 s93, s98, 0x14400
    s_mov_b32 m0, s93
    s_nop 0
    buffer_load_dwordx4 v32, s[76:79], s92 offen lds
    s_add_u32 s92, s99, 0x290000
    s_add_u32 s93, s98, 0x14800
    s_mov_b32 m0, s93
    s_nop 0
    buffer_load_dwordx4 v33, s[76:79], s92 offen lds
    s_add_u32 s92, s99, 0x298000
    s_add_u32 s93, s98, 0x14c00
    s_mov_b32 m0, s93
    s_nop 0
    buffer_load_dwordx4 v33, s[76:79], s92 offen lds
    ds_read_b64_tr_b16 a[176:177], v38 offset:32768
    ds_read_b64_tr_b16 a[178:179], v38 offset:33792
    ds_read_b64_tr_b16 a[180:181], v38 offset:40960
    ds_read_b64_tr_b16 a[182:183], v38 offset:41984
    ds_read_b64_tr_b16 a[240:241], v39 offset:32768
    ds_read_b64_tr_b16 a[242:243], v39 offset:33792
    ds_read_b64_tr_b16 a[244:245], v39 offset:40960
    ds_read_b64_tr_b16 a[246:247], v39 offset:41984
    s_waitcnt lgkmcnt(0)
    s_waitcnt vmcnt(24)
    s_barrier
    v_mov_b32 v44, 1
    buffer_atomic_add v44, v31, s[24:27], 0 offen
    s_add_u32 s92, s99, 0x300000
    s_add_u32 s93, s98, 0x18000
    s_mov_b32 m0, s93
    s_nop 0
    buffer_load_dwordx4 v32, s[76:79], s92 offen lds
    s_add_u32 s92, s99, 0x308000
    s_add_u32 s93, s98, 0x18400
    s_mov_b32 m0, s93
    s_nop 0
    buffer_load_dwordx4 v32, s[76:79], s92 offen lds
    s_add_u32 s92, s99, 0x310000
    s_add_u32 s93, s98, 0x18800
    s_mov_b32 m0, s93
    s_nop 0
    buffer_load_dwordx4 v33, s[76:79], s92 offen lds
    s_add_u32 s92, s99, 0x318000
    s_add_u32 s93, s98, 0x18c00
    s_mov_b32 m0, s93
    s_nop 0
    buffer_load_dwordx4 v33, s[76:79], s92 offen lds
    ds_read_b64_tr_b16 a[184:185], v38 offset:49152
    ds_read_b64_tr_b16 a[186:187], v38 offset:50176
    ds_read_b64_tr_b16 a[188:189], v38 offset:57344
    ds_read_b64_tr_b16 a[190:191], v38 offset:58368
    ds_read_b64_tr_b16 a[248:249], v39 offset:49152
    ds_read_b64_tr_b16 a[250:251], v39 offset:50176
    ds_read_b64_tr_b16 a[252:253], v39 offset:57344
    ds_read_b64_tr_b16 a[254:255], v39 offset:58368
    s_waitcnt lgkmcnt(0)
    s_waitcnt vmcnt(25)
    s_barrier
    s_add_u32 s92, s99, 0x380000
    s_add_u32 s93, s98, 0x1c000
    s_mov_b32 m0, s93
    s_nop 0
    buffer_load_dwordx4 v32, s[76:79], s92 offen lds
    s_add_u32 s92, s99, 0x388000
    s_add_u32 s93, s98, 0x1c400
    s_mov_b32 m0, s93
    s_nop 0
    buffer_load_dwordx4 v32, s[76:79], s92 offen lds
    s_add_u32 s92, s99, 0x390000
    s_add_u32 s93, s98, 0x1c800
    s_mov_b32 m0, s93
    s_nop 0
    buffer_load_dwordx4 v33, s[76:79], s92 offen lds
    s_add_u32 s92, s99, 0x398000
    s_add_u32 s93, s98, 0x1cc00
    s_mov_b32 m0, s93
    s_nop 0
    buffer_load_dwordx4 v33, s[76:79], s92 offen lds
    ds_read_b64_tr_b16 v[128:129], v36 offset:0
    ds_read_b64_tr_b16 v[130:131], v36 offset:1024
    ds_read_b64_tr_b16 v[132:133], v36 offset:8192
    ds_read_b64_tr_b16 v[134:135], v36 offset:9216
    ds_read_b64_tr_b16 v[192:193], v37 offset:0
    ds_read_b64_tr_b16 v[194:195], v37 offset:1024
    ds_read_b64_tr_b16 v[196:197], v37 offset:8192
    ds_read_b64_tr_b16 v[198:199], v37 offset:9216
    s_waitcnt lgkmcnt(0)
    s_waitcnt vmcnt(25)
    s_barrier
    s_add_u32 s92, s99, 0x0
    s_add_u32 s93, s98, 0x0
    s_mov_b32 m0, s93
    s_nop 0
    buffer_load_dwordx4 v32, s[68:71], s92 offen lds
    s_add_u32 s92, s99, 0x8000
    s_add_u32 s93, s98, 0x400
    s_mov_b32 m0, s93
    s_nop 0
    buffer_load_dwordx4 v32, s[68:71], s92 offen lds
    s_add_u32 s92, s99, 0x10000
    s_add_u32 s93, s98, 0x800
    s_mov_b32 m0, s93
    s_nop 0
    buffer_load_dwordx4 v33, s[68:71], s92 offen lds
    s_add_u32 s92, s99, 0x18000
    s_add_u32 s93, s98, 0xc00
    s_mov_b32 m0, s93
    s_nop 0
    buffer_load_dwordx4 v33, s[68:71], s92 offen lds
    ds_read_b64_tr_b16 v[136:137], v36 offset:16384
    ds_read_b64_tr_b16 v[138:139], v36 offset:17408
    ds_read_b64_tr_b16 v[140:141], v36 offset:24576
    ds_read_b64_tr_b16 v[142:143], v36 offset:25600
    ds_read_b64_tr_b16 v[200:201], v37 offset:16384
    ds_read_b64_tr_b16 v[202:203], v37 offset:17408
    ds_read_b64_tr_b16 v[204:205], v37 offset:24576
    ds_read_b64_tr_b16 v[206:207], v37 offset:25600
    s_waitcnt lgkmcnt(0)
    s_waitcnt vmcnt(25)
    s_barrier
    s_add_u32 s92, s99, 0x80000
    s_add_u32 s93, s98, 0x4000
    s_mov_b32 m0, s93
    s_nop 0
    buffer_load_dwordx4 v32, s[68:71], s92 offen lds
    s_add_u32 s92, s99, 0x88000
    s_add_u32 s93, s98, 0x4400
    s_mov_b32 m0, s93
    s_nop 0
    buffer_load_dwordx4 v32, s[68:71], s92 offen lds
    s_add_u32 s92, s99, 0x90000
    s_add_u32 s93, s98, 0x4800
    s_mov_b32 m0, s93
    s_nop 0
    buffer_load_dwordx4 v33, s[68:71], s92 offen lds
    s_add_u32 s92, s99, 0x98000
    s_add_u32 s93, s98, 0x4c00
    s_mov_b32 m0, s93
    s_nop 0
    buffer_load_dwordx4 v33, s[68:71], s92 offen lds
    ds_read_b64_tr_b16 v[144:145], v36 offset:32768
    ds_read_b64_tr_b16 v[146:147], v36 offset:33792
    ds_read_b64_tr_b16 v[148:149], v36 offset:40960
    ds_read_b64_tr_b16 v[150:151], v36 offset:41984
    ds_read_b64_tr_b16 v[208:209], v37 offset:32768
    ds_read_b64_tr_b16 v[210:211], v37 offset:33792
    ds_read_b64_tr_b16 v[212:213], v37 offset:40960
    ds_read_b64_tr_b16 v[214:215], v37 offset:41984
    s_waitcnt lgkmcnt(0)
    s_waitcnt vmcnt(25)
    s_barrier
    s_add_u32 s92, s99, 0x100000
    s_add_u32 s93, s98, 0x8000
    s_mov_b32 m0, s93
    s_nop 0
    buffer_load_dwordx4 v32, s[68:71], s92 offen lds
    s_add_u32 s92, s99, 0x108000
    s_add_u32 s93, s98, 0x8400
    s_mov_b32 m0, s93
    s_nop 0
    buffer_load_dwordx4 v32, s[68:71], s92 offen lds
    s_add_u32 s92, s99, 0x110000
    s_add_u32 s93, s98, 0x8800
    s_mov_b32 m0, s93
    s_nop 0
    buffer_load_dwordx4 v33, s[68:71], s92 offen lds
    s_add_u32 s92, s99, 0x118000
    s_add_u32 s93, s98, 0x8c00
    s_mov_b32 m0, s93
    s_nop 0
    buffer_load_dwordx4 v33, s[68:71], s92 offen lds
    ds_read_b64_tr_b16 v[152:153], v36 offset:49152
    ds_read_b64_tr_b16 v[154:155], v36 offset:50176
    ds_read_b64_tr_b16 v[156:157], v36 offset:57344
    ds_read_b64_tr_b16 v[158:159], v36 offset:58368
    ds_read_b64_tr_b16 v[216:217], v37 offset:49152
    ds_read_b64_tr_b16 v[218:219], v37 offset:50176
    ds_read_b64_tr_b16 v[220:221], v37 offset:57344
    ds_read_b64_tr_b16 v[222:223], v37 offset:58368
    s_waitcnt lgkmcnt(0)
    s_waitcnt vmcnt(25)
    s_barrier
    s_add_u32 s92, s99, 0x180000
    s_add_u32 s93, s98, 0xc000
    s_mov_b32 m0, s93
    s_nop 0
    buffer_load_dwordx4 v32, s[68:71], s92 offen lds
    s_add_u32 s92, s99, 0x188000
    s_add_u32 s93, s98, 0xc400
    s_mov_b32 m0, s93
    s_nop 0
    buffer_load_dwordx4 v32, s[68:71], s92 offen lds
    s_add_u32 s92, s99, 0x190000
    s_add_u32 s93, s98, 0xc800
    s_mov_b32 m0, s93
    s_nop 0
    buffer_load_dwordx4 v33, s[68:71], s92 offen lds
    s_add_u32 s92, s99, 0x198000
    s_add_u32 s93, s98, 0xcc00
    s_mov_b32 m0, s93
    s_nop 0
    buffer_load_dwordx4 v33, s[68:71], s92 offen lds
    ds_read_b64_tr_b16 v[160:161], v38 offset:0
    ds_read_b64_tr_b16 v[162:163], v38 offset:1024
    ds_read_b64_tr_b16 v[164:165], v38 offset:8192
    ds_read_b64_tr_b16 v[166:167], v38 offset:9216
    ds_read_b64_tr_b16 v[224:225], v39 offset:0
    ds_read_b64_tr_b16 v[226:227], v39 offset:1024
    ds_read_b64_tr_b16 v[228:229], v39 offset:8192
    ds_read_b64_tr_b16 v[230:231], v39 offset:9216
    s_waitcnt lgkmcnt(0)
    s_waitcnt vmcnt(25)
    s_barrier
    s_add_u32 s92, s99, 0x200000
    s_add_u32 s93, s98, 0x10000
    s_mov_b32 m0, s93
    s_nop 0
    buffer_load_dwordx4 v32, s[68:71], s92 offen lds
    s_add_u32 s92, s99, 0x208000
    s_add_u32 s93, s98, 0x10400
    s_mov_b32 m0, s93
    s_nop 0
    buffer_load_dwordx4 v32, s[68:71], s92 offen lds
    s_add_u32 s92, s99, 0x210000
    s_add_u32 s93, s98, 0x10800
    s_mov_b32 m0, s93
    s_nop 0
    buffer_load_dwordx4 v33, s[68:71], s92 offen lds
    s_add_u32 s92, s99, 0x218000
    s_add_u32 s93, s98, 0x10c00
    s_mov_b32 m0, s93
    s_nop 0
    buffer_load_dwordx4 v33, s[68:71], s92 offen lds
    ds_read_b64_tr_b16 v[168:169], v38 offset:16384
    ds_read_b64_tr_b16 v[170:171], v38 offset:17408
    ds_read_b64_tr_b16 v[172:173], v38 offset:24576
    ds_read_b64_tr_b16 v[174:175], v38 offset:25600
    ds_read_b64_tr_b16 v[232:233], v39 offset:16384
    ds_read_b64_tr_b16 v[234:235], v39 offset:17408
    ds_read_b64_tr_b16 v[236:237], v39 offset:24576
    ds_read_b64_tr_b16 v[238:239], v39 offset:25600
    s_waitcnt lgkmcnt(0)
    s_waitcnt vmcnt(24)
    s_barrier
    s_add_u32 s92, s99, 0x280000
    s_add_u32 s93, s98, 0x14000
    s_mov_b32 m0, s93
    s_nop 0
    buffer_load_dwordx4 v32, s[68:71], s92 offen lds
    s_add_u32 s92, s99, 0x288000
    s_add_u32 s93, s98, 0x14400
    s_mov_b32 m0, s93
    s_nop 0
    buffer_load_dwordx4 v32, s[68:71], s92 offen lds
    s_add_u32 s92, s99, 0x290000
    s_add_u32 s93, s98, 0x14800
    s_mov_b32 m0, s93
    s_nop 0
    buffer_load_dwordx4 v33, s[68:71], s92 offen lds
    s_add_u32 s92, s99, 0x298000
    s_add_u32 s93, s98, 0x14c00
    s_mov_b32 m0, s93
    s_nop 0
    buffer_load_dwordx4 v33, s[68:71], s92 offen lds
    ds_read_b64_tr_b16 v[176:177], v38 offset:32768
    ds_read_b64_tr_b16 v[178:179], v38 offset:33792
    ds_read_b64_tr_b16 v[180:181], v38 offset:40960
    ds_read_b64_tr_b16 v[182:183], v38 offset:41984
    ds_read_b64_tr_b16 v[240:241], v39 offset:32768
    ds_read_b64_tr_b16 v[242:243], v39 offset:33792
    ds_read_b64_tr_b16 v[244:245], v39 offset:40960
    ds_read_b64_tr_b16 v[246:247], v39 offset:41984
    s_waitcnt lgkmcnt(0)
    s_waitcnt vmcnt(24)
    s_barrier
    s_add_u32 s92, s99, 0x300000
    s_add_u32 s93, s98, 0x18000
    s_mov_b32 m0, s93
    s_nop 0
    buffer_load_dwordx4 v32, s[68:71], s92 offen lds
    s_add_u32 s92, s99, 0x308000
    s_add_u32 s93, s98, 0x18400
    s_mov_b32 m0, s93
    s_nop 0
    buffer_load_dwordx4 v32, s[68:71], s92 offen lds
    s_add_u32 s92, s99, 0x310000
    s_add_u32 s93, s98, 0x18800
    s_mov_b32 m0, s93
    s_nop 0
    buffer_load_dwordx4 v33, s[68:71], s92 offen lds
    s_add_u32 s92, s99, 0x318000
    s_add_u32 s93, s98, 0x18c00
    s_mov_b32 m0, s93
    s_nop 0
    buffer_load_dwordx4 v33, s[68:71], s92 offen lds
    ds_read_b64_tr_b16 v[184:185], v38 offset:49152
    ds_read_b64_tr_b16 v[186:187], v38 offset:50176
    ds_read_b64_tr_b16 v[188:189], v38 offset:57344
    ds_read_b64_tr_b16 v[190:191], v38 offset:58368
    ds_read_b64_tr_b16 v[248:249], v39 offset:49152
    ds_read_b64_tr_b16 v[250:251], v39 offset:50176
    ds_read_b64_tr_b16 v[252:253], v39 offset:57344
    ds_read_b64_tr_b16 v[254:255], v39 offset:58368
    s_waitcnt lgkmcnt(0)
    s_waitcnt vmcnt(24)
    s_barrier
    s_add_u32 s92, s99, 0x380000
    s_add_u32 s93, s98, 0x1c000
    s_mov_b32 m0, s93
    s_nop 0
    buffer_load_dwordx4 v32, s[68:71], s92 offen lds
    s_add_u32 s92, s99, 0x388000
    s_add_u32 s93, s98, 0x1c400
    s_mov_b32 m0, s93
    s_nop 0
    buffer_load_dwordx4 v32, s[68:71], s92 offen lds
    s_add_u32 s92, s99, 0x390000
    s_add_u32 s93, s98, 0x1c800
    s_mov_b32 m0, s93
    s_nop 0
    buffer_load_dwordx4 v33, s[68:71], s92 offen lds
    s_add_u32 s92, s99, 0x398000
    s_add_u32 s93, s98, 0x1cc00
    s_mov_b32 m0, s93
    s_nop 0
    buffer_load_dwordx4 v33, s[68:71], s92 offen lds
    ds_read_b64_tr_b16 a[0:1], v36 offset:0
    ds_read_b64_tr_b16 a[2:3], v36 offset:1024
    ds_read_b64_tr_b16 a[4:5], v36 offset:8192
    ds_read_b64_tr_b16 a[6:7], v36 offset:9216
    ds_read_b64_tr_b16 a[64:65], v37 offset:0
    ds_read_b64_tr_b16 a[66:67], v37 offset:1024
    ds_read_b64_tr_b16 a[68:69], v37 offset:8192
    ds_read_b64_tr_b16 a[70:71], v37 offset:9216
    s_waitcnt lgkmcnt(0)
    s_waitcnt vmcnt(24)
    s_barrier
    s_add_u32 s92, s100, 0x0
    s_add_u32 s93, s98, 0x0
    s_mov_b32 m0, s93
    s_nop 0
    buffer_load_dwordx4 v60, s[84:87], s92 offen lds
    s_add_u32 s92, s100, 0x5600
    s_add_u32 s93, s98, 0x400
    s_mov_b32 m0, s93
    s_nop 0
    buffer_load_dwordx4 v61, s[84:87], s92 offen lds
    s_add_u32 s92, s100, 0xac00
    s_add_u32 s93, s98, 0x800
    s_mov_b32 m0, s93
    s_nop 0
    buffer_load_dwordx4 v60, s[84:87], s92 offen lds
    s_add_u32 s92, s100, 0x10200
    s_add_u32 s93, s98, 0xc00
    s_mov_b32 m0, s93
    s_nop 0
    buffer_load_dwordx4 v61, s[84:87], s92 offen lds
    ds_read_b64_tr_b16 a[8:9], v36 offset:16384
    ds_read_b64_tr_b16 a[10:11], v36 offset:17408
    ds_read_b64_tr_b16 a[12:13], v36 offset:24576
    ds_read_b64_tr_b16 a[14:15], v36 offset:25600
    ds_read_b64_tr_b16 a[72:73], v37 offset:16384
    ds_read_b64_tr_b16 a[74:75], v37 offset:17408
    ds_read_b64_tr_b16 a[76:77], v37 offset:24576
    ds_read_b64_tr_b16 a[78:79], v37 offset:25600
    s_waitcnt lgkmcnt(0)
    s_waitcnt vmcnt(24)
    s_barrier
    s_add_u32 s92, s100, 0x56000
    s_add_u32 s93, s98, 0x4000
    s_mov_b32 m0, s93
    s_nop 0
    buffer_load_dwordx4 v60, s[84:87], s92 offen lds
    s_add_u32 s92, s100, 0x5b600
    s_add_u32 s93, s98, 0x4400
    s_mov_b32 m0, s93
    s_nop 0
    buffer_load_dwordx4 v61, s[84:87], s92 offen lds
    s_add_u32 s92, s100, 0x60c00
    s_add_u32 s93, s98, 0x4800
    s_mov_b32 m0, s93
    s_nop 0
    buffer_load_dwordx4 v60, s[84:87], s92 offen lds
    s_add_u32 s92, s100, 0x66200
    s_add_u32 s93, s98, 0x4c00
    s_mov_b32 m0, s93
    s_nop 0
    buffer_load_dwordx4 v61, s[84:87], s92 offen lds
    ds_read_b64_tr_b16 a[16:17], v36 offset:32768
    ds_read_b64_tr_b16 a[18:19], v36 offset:33792
    ds_read_b64_tr_b16 a[20:21], v36 offset:40960
    ds_read_b64_tr_b16 a[22:23], v36 offset:41984
    ds_read_b64_tr_b16 a[80:81], v37 offset:32768
    ds_read_b64_tr_b16 a[82:83], v37 offset:33792
    ds_read_b64_tr_b16 a[84:85], v37 offset:40960
    ds_read_b64_tr_b16 a[86:87], v37 offset:41984
    s_waitcnt lgkmcnt(0)
    s_waitcnt vmcnt(24)
    s_barrier
    s_add_u32 s92, s100, 0xac000
    s_add_u32 s93, s98, 0x8000
    s_mov_b32 m0, s93
    s_nop 0
    buffer_load_dwordx4 v60, s[84:87], s92 offen lds
    s_add_u32 s92, s100, 0xb1600
    s_add_u32 s93, s98, 0x8400
    s_mov_b32 m0, s93
    s_nop 0
    buffer_load_dwordx4 v61, s[84:87], s92 offen lds
    s_add_u32 s92, s100, 0xb6c00
    s_add_u32 s93, s98, 0x8800
    s_mov_b32 m0, s93
    s_nop 0
    buffer_load_dwordx4 v60, s[84:87], s92 offen lds
    s_add_u32 s92, s100, 0xbc200
    s_add_u32 s93, s98, 0x8c00
    s_mov_b32 m0, s93
    s_nop 0
    buffer_load_dwordx4 v61, s[84:87], s92 offen lds
    ds_read_b64_tr_b16 a[24:25], v36 offset:49152
    ds_read_b64_tr_b16 a[26:27], v36 offset:50176
    ds_read_b64_tr_b16 a[28:29], v36 offset:57344
    ds_read_b64_tr_b16 a[30:31], v36 offset:58368
    ds_read_b64_tr_b16 a[88:89], v37 offset:49152
    ds_read_b64_tr_b16 a[90:91], v37 offset:50176
    ds_read_b64_tr_b16 a[92:93], v37 offset:57344
    ds_read_b64_tr_b16 a[94:95], v37 offset:58368
    s_waitcnt lgkmcnt(0)
    s_waitcnt vmcnt(24)
    s_barrier
    s_add_u32 s92, s100, 0x102000
    s_add_u32 s93, s98, 0xc000
    s_mov_b32 m0, s93
    s_nop 0
    buffer_load_dwordx4 v60, s[84:87], s92 offen lds
    s_add_u32 s92, s100, 0x107600
    s_add_u32 s93, s98, 0xc400
    s_mov_b32 m0, s93
    s_nop 0
    buffer_load_dwordx4 v61, s[84:87], s92 offen lds
    s_add_u32 s92, s100, 0x10cc00
    s_add_u32 s93, s98, 0xc800
    s_mov_b32 m0, s93
    s_nop 0
    buffer_load_dwordx4 v60, s[84:87], s92 offen lds
    s_add_u32 s92, s100, 0x112200
    s_add_u32 s93, s98, 0xcc00
    s_mov_b32 m0, s93
    s_nop 0
    buffer_load_dwordx4 v61, s[84:87], s92 offen lds
    ds_read_b64_tr_b16 a[32:33], v38 offset:0
    ds_read_b64_tr_b16 a[34:35], v38 offset:1024
    ds_read_b64_tr_b16 a[36:37], v38 offset:8192
    ds_read_b64_tr_b16 a[38:39], v38 offset:9216
    ds_read_b64_tr_b16 a[96:97], v39 offset:0
    ds_read_b64_tr_b16 a[98:99], v39 offset:1024
    ds_read_b64_tr_b16 a[100:101], v39 offset:8192
    ds_read_b64_tr_b16 a[102:103], v39 offset:9216
    s_waitcnt lgkmcnt(0)
    s_waitcnt vmcnt(24)
    s_barrier
    s_lshl_b32 s94, s29, 15
    s_add_u32 s92, s94, s98
    s_add_u32 s92, s92, 0x0
    s_add_u32 s93, s98, 0x10000
    s_mov_b32 m0, s93
    s_nop 0
    buffer_load_dwordx4 v20, s[12:15], s92 offen lds
    s_add_u32 s92, s94, s98
    s_add_u32 s92, s92, 0x400
    s_add_u32 s93, s98, 0x10400
    s_mov_b32 m0, s93
    s_nop 0
    buffer_load_dwordx4 v21, s[12:15], s92 offen lds
    s_add_u32 s92, s94, s98
    s_add_u32 s92, s92, 0x800
    s_add_u32 s93, s98, 0x10800
    s_mov_b32 m0, s93
    s_nop 0
    buffer_load_dwordx4 v22, s[12:15], s92 offen lds
    s_add_u32 s92, s94, s98
    s_add_u32 s92, s92, 0xc00
    s_add_u32 s93, s98, 0x10c00
    s_mov_b32 m0, s93
    s_nop 0
    buffer_load_dwordx4 v23, s[12:15], s92 offen lds
    ds_read_b64_tr_b16 a[40:41], v38 offset:16384
    ds_read_b64_tr_b16 a[42:43], v38 offset:17408
    ds_read_b64_tr_b16 a[44:45], v38 offset:24576
    ds_read_b64_tr_b16 a[46:47], v38 offset:25600
    ds_read_b64_tr_b16 a[104:105], v39 offset:16384
    ds_read_b64_tr_b16 a[106:107], v39 offset:17408
    ds_read_b64_tr_b16 a[108:109], v39 offset:24576
    ds_read_b64_tr_b16 a[110:111], v39 offset:25600
    s_waitcnt lgkmcnt(0)
    s_waitcnt vmcnt(24)
    s_barrier
    s_lshl_b32 s94, s29, 15
    s_add_u32 s92, s94, s98
    s_add_u32 s92, s92, 0x4000
    s_add_u32 s93, s98, 0x14000
    s_mov_b32 m0, s93
    s_nop 0
    buffer_load_dwordx4 v20, s[12:15], s92 offen lds
    s_add_u32 s92, s94, s98
    s_add_u32 s92, s92, 0x4400
    s_add_u32 s93, s98, 0x14400
    s_mov_b32 m0, s93
    s_nop 0
    buffer_load_dwordx4 v21, s[12:15], s92 offen lds
    s_add_u32 s92, s94, s98
    s_add_u32 s92, s92, 0x4800
    s_add_u32 s93, s98, 0x14800
    s_mov_b32 m0, s93
    s_nop 0
    buffer_load_dwordx4 v22, s[12:15], s92 offen lds
    s_add_u32 s92, s94, s98
    s_add_u32 s92, s92, 0x4c00
    s_add_u32 s93, s98, 0x14c00
    s_mov_b32 m0, s93
    s_nop 0
    buffer_load_dwordx4 v23, s[12:15], s92 offen lds
    ds_read_b64_tr_b16 a[48:49], v38 offset:32768
    ds_read_b64_tr_b16 a[50:51], v38 offset:33792
    ds_read_b64_tr_b16 a[52:53], v38 offset:40960
    ds_read_b64_tr_b16 a[54:55], v38 offset:41984
    ds_read_b64_tr_b16 a[112:113], v39 offset:32768
    ds_read_b64_tr_b16 a[114:115], v39 offset:33792
    ds_read_b64_tr_b16 a[116:117], v39 offset:40960
    ds_read_b64_tr_b16 a[118:119], v39 offset:41984
    s_waitcnt lgkmcnt(0)
    s_waitcnt vmcnt(24)
    s_barrier
    ds_read_b64_tr_b16 a[56:57], v38 offset:49152
    ds_read_b64_tr_b16 a[58:59], v38 offset:50176
    ds_read_b64_tr_b16 a[60:61], v38 offset:57344
    ds_read_b64_tr_b16 a[62:63], v38 offset:58368
    ds_read_b64_tr_b16 a[120:121], v39 offset:49152
    ds_read_b64_tr_b16 a[122:123], v39 offset:50176
    ds_read_b64_tr_b16 a[124:125], v39 offset:57344
    ds_read_b64_tr_b16 a[126:127], v39 offset:58368
    s_waitcnt lgkmcnt(0)
    s_waitcnt vmcnt(20)
    s_barrier
    s_waitcnt vmcnt(16)
    s_barrier
    s_waitcnt vmcnt(12)
    s_barrier
    s_waitcnt vmcnt(8)
    s_barrier
    s_waitcnt vmcnt(4)
    s_barrier
    s_waitcnt vmcnt(0)
    s_barrier
    v_bfe_u32 v50, v0, 1, 1
    v_bfe_u32 v51, v0, 3, 1
    v_lshl_or_b32 v50, v51, 1, v50
    v_xor_b32 v50, 3, v50
    v_lshlrev_b32 v50, 5, v50
    v_lshl_or_b32 v50, v0, 7, v50
    v_lshl_or_b32 v66, v62, 16, v62
    v_mov_b32 v67, v66
    v_mov_b32 v68, v66
    v_mov_b32 v69, v66
    ds_write_b128 v50, v[66:69] offset:0
    ds_write_b128 v50, v[66:69] offset:16
    s_waitcnt lgkmcnt(0)
    v_lshl_or_b32 v66, v63, 16, v63
    v_mov_b32 v67, v66
    v_mov_b32 v68, v66
    v_mov_b32 v69, v66
    ds_write_b128 v50, v[66:69] offset:32768
    ds_write_b128 v50, v[66:69] offset:32784
    s_waitcnt lgkmcnt(0)
    v_lshlrev_b32 v16, 16, v64
    v_and_b32 v17, 0xffff0000, v64
    v_lshlrev_b32 v18, 16, v65
    v_and_b32 v19, 0xffff0000, v65
    v_and_b32 v50, 15, v3
    v_lshrrev_b32 v51, 4, v3
    v_or_b32 v52, 0, v51
    v_xor_b32 v52, v52, v50
    v_lshlrev_b32 v52, 4, v52
    v_lshl_or_b32 v52, v50, 10, v52
    v_add_u32 v4, 0x10000, v52
    v_or_b32 v52, 4, v51
    v_xor_b32 v52, v52, v50
    v_lshlrev_b32 v52, 4, v52
    v_lshl_or_b32 v52, v50, 10, v52
    v_add_u32 v5, 0x10000, v52
    v_or_b32 v52, 8, v51
    v_xor_b32 v52, v52, v50
    v_lshlrev_b32 v52, 4, v52
    v_lshl_or_b32 v52, v50, 10, v52
    v_add_u32 v6, 0x10000, v52
    v_or_b32 v52, 12, v51
    v_xor_b32 v52, v52, v50
    v_lshlrev_b32 v52, 4, v52
    v_lshl_or_b32 v52, v50, 10, v52
    v_add_u32 v7, 0x10000, v52
    v_bfe_u32 v52, v3, 3, 1
    v_and_b32 v53, 1, v51
    v_lshl_or_b32 v52, v53, 1, v52
    v_xor_b32 v52, s64, v52
    v_lshlrev_b32 v52, 5, v52
    v_bfe_u32 v53, v3, 2, 2
    v_lshl_add_u32 v53, v51, 3, v53
    v_lshl_or_b32 v52, v53, 7, v52
    v_and_b32 v53, 3, v3
    v_lshl_or_b32 v8, v53, 3, v52
    s_lshl_b32 s4, s64, 3
    v_add_u32 v24, s4, v1
    v_lshlrev_b32 v52, 3, v3
    v_add_u32 v52, 1024, v52
    v_lshlrev_b32 v53, 2, v3
    v_add_u32 v53, 3072, v53
    s_cmp_eq_u32 s64, 2
    s_cselect_b64 vcc, -1, 0
    v_cndmask_b32 v24, v24, v52, vcc
    s_cmp_eq_u32 s64, 3
    s_cselect_b64 vcc, -1, 0
    v_cndmask_b32 v24, v24, v53, vcc
    v_cmp_eq_u32 vcc, 0, v0
    s_nop 1
    v_cndmask_b32 v25, v54, v0, vcc
    v_lshlrev_b32 v71, 2, v3
L_gate_2:
    buffer_load_dword v70, v71, s[24:27], 0 offen sc1
    s_waitcnt vmcnt(0)
    v_readlane_b32 s93, v70, 2
    v_readlane_b32 s94, v70, 18
    s_nop 0
    s_add_u32 s93, s93, s94
    v_readlane_b32 s94, v70, 34
    s_nop 0
    s_add_u32 s93, s93, s94
    v_readlane_b32 s94, v70, 50
    s_nop 0
    s_add_u32 s93, s93, s94
    v_readlane_b32 s94, v70, 3
    s_nop 0
    s_add_u32 s93, s93, s94
    v_readlane_b32 s94, v70, 19
    s_nop 0
    s_add_u32 s93, s93, s94
    v_readlane_b32 s94, v70, 35
    s_nop 0
    s_add_u32 s93, s93, s94
    v_readlane_b32 s94, v70, 51
    s_nop 0
    s_add_u32 s93, s93, s94
    v_readlane_b32 s92, v70, 0
    s_cmp_eq_u32 s93, 256
    s_cbranch_scc1 L_gate_2_ok
    s_sleep 2
    s_sub_u32 s28, s28, 1
    s_cbranch_scc1 L_fail
    s_branch L_gate_2
L_gate_2_ok:
    s_mov_b32 s95, 0x18000
    s_mov_b32 s96, -1
    s_lshl_b32 s99, s64, 10
L_p1:
    s_barrier
    ds_read_b128 v[88:91], v4 offset:0
    ds_read_b128 v[92:95], v4 offset:16384
    ds_read_b64_tr_b16 v[104:105], v8 offset:0
    ds_read_b64_tr_b16 v[106:107], v8 offset:512
    s_add_u32 s97, s29, 7
    s_lshl_b32 s94, s97, 15
    s_add_u32 s94, s94, s98
    s_add_u32 s93, s95, s98
    ds_read_b128 v[96:99], v5 offset:0
    ds_read_b128 v[100:103], v5 offset:16384
    ds_read_b64_tr_b16 v[108:109], v8 offset:4096
    ds_read_b64_tr_b16 v[110:111], v8 offset:4608
    s_waitcnt lgkmcnt(4)
    v_mfma_f32_16x16x32_bf16 v[80:83], v[104:107], v[88:91], v[16:19]
    s_add_u32 s4, s93, 0
    v_mfma_f32_16x16x32_bf16 v[84:87], v[104:107], v[92:95], v[16:19]
    s_add_u32 s92, s94, 0
    v_mfma_f32_16x16x32_bf16 v[48:51], a[128:131], v[88:91], 0
    s_mov_b32 m0, s4
    v_mfma_f32_16x16x32_bf16 v[52:55], a[192:195], v[88:91], 0
    buffer_load_dwordx4 v20, s[12:15], s92 offen lds
    v_mfma_f32_16x16x32_bf16 v[56:59], a[128:131], v[92:95], 0
    s_add_u32 s4, s93, 16384
    v_mfma_f32_16x16x32_bf16 v[60:63], a[192:195], v[92:95], 0
    s_add_u32 s92, s94, 16384
    v_mfma_f32_16x16x32_bf16 v[64:67], v[88:91], v[128:131], 0
    s_mov_b32 m0, s4
    v_mfma_f32_16x16x32_bf16 v[72:75], v[88:91], v[192:195], 0
    buffer_load_dwordx4 v20, s[12:15], s92 offen lds
    v_mfma_f32_16x16x32_bf16 v[68:71], v[92:95], v[128:131], 0
    v_mfma_f32_16x16x32_bf16 v[76:79], v[92:95], v[192:195], 0
    v_mfma_f32_16x16x32_bf16 v[32:35], a[0:3], v[88:91], 0
    v_mfma_f32_16x16x32_bf16 v[36:39], a[64:67], v[88:91], 0
    v_mfma_f32_16x16x32_bf16 v[40:43], a[0:3], v[92:95], 0
    v_mfma_f32_16x16x32_bf16 v[44:47], a[64:67], v[92:95], 0
    ds_read_b128 v[88:91], v6 offset:0
    ds_read_b128 v[92:95], v6 offset:16384
    ds_read_b64_tr_b16 v[104:105], v8 offset:8192
    ds_read_b64_tr_b16 v[106:107], v8 offset:8704
    s_waitcnt lgkmcnt(4)
    v_mfma_f32_16x16x32_bf16 v[80:83], v[108:111], v[96:99], v[80:83]
    s_add_u32 s4, s93, 1024
    v_mfma_f32_16x16x32_bf16 v[84:87], v[108:111], v[100:103], v[84:87]
    s_add_u32 s92, s94, 1024
    v_mfma_f32_16x16x32_bf16 v[48:51], a[132:135], v[96:99], v[48:51]
    s_mov_b32 m0, s4
    v_mfma_f32_16x16x32_bf16 v[52:55], a[196:199], v[96:99], v[52:55]
    buffer_load_dwordx4 v21, s[12:15], s92 offen lds
    v_mfma_f32_16x16x32_bf16 v[56:59], a[132:135], v[100:103], v[56:59]
    s_add_u32 s4, s93, 17408
    v_mfma_f32_16x16x32_bf16 v[60:63], a[196:199], v[100:103], v[60:63]
    s_add_u32 s92, s94, 17408
    v_mfma_f32_16x16x32_bf16 v[64:67], v[96:99], v[132:135], v[64:67]
    s_mov_b32 m0, s4
    v_mfma_f32_16x16x32_bf16 v[72:75], v[96:99], v[196:199], v[72:75]
    buffer_load_dwordx4 v21, s[12:15], s92 offen lds
    v_mfma_f32_16x16x32_bf16 v[68:71], v[100:103], v[132:135], v[68:71]
    v_mfma_f32_16x16x32_bf16 v[76:79], v[100:103], v[196:199], v[76:79]
    v_mfma_f32_16x16x32_bf16 v[32:35], a[4:7], v[96:99], v[32:35]
    v_mfma_f32_16x16x32_bf16 v[36:39], a[68:71], v[96:99], v[36:39]
    v_mfma_f32_16x16x32_bf16 v[40:43], a[4:7], v[100:103], v[40:43]
    v_mfma_f32_16x16x32_bf16 v[44:47], a[68:71], v[100:103], v[44:47]
    ds_read_b128 v[96:99], v7 offset:0
    ds_read_b128 v[100:103], v7 offset:16384
    ds_read_b64_tr_b16 v[108:109], v8 offset:12288
    ds_read_b64_tr_b16 v[110:111], v8 offset:12800
    s_waitcnt lgkmcnt(4)
    v_mfma_f32_16x16x32_bf16 v[80:83], v[104:107], v[88:91], v[80:83]
    s_add_u32 s4, s93, 2048
    v_mfma_f32_16x16x32_bf16 v[84:87], v[104:107], v[92:95], v[84:87]
    s_add_u32 s92, s94, 2048
    v_mfma_f32_16x16x32_bf16 v[48:51], a[136:139], v[88:91], v[48:51]
    s_mov_b32 m0, s4
    v_mfma_f32_16x16x32_bf16 v[52:55], a[200:203], v[88:91], v[52:55]
    buffer_load_dwordx4 v22, s[12:15], s92 offen lds
    v_mfma_f32_16x16x32_bf16 v[56:59], a[136:139], v[92:95], v[56:59]
    s_add_u32 s4, s93, 18432
    v_mfma_f32_16x16x32_bf16 v[60:63], a[200:203], v[92:95], v[60:63]
    s_add_u32 s92, s94, 18432
    v_mfma_f32_16x16x32_bf16 v[64:67], v[88:91], v[136:139], v[64:67]
    s_mov_b32 m0, s4
    v_mfma_f32_16x16x32_bf16 v[72:75], v[88:91], v[200:203], v[72:75]
    buffer_load_dwordx4 v22, s[12:15], s92 offen lds
    v_mfma_f32_16x16x32_bf16 v[68:71], v[92:95], v[136:139], v[68:71]
    v_mfma_f32_16x16x32_bf16 v[76:79], v[92:95], v[200:203], v[76:79]
    v_mfma_f32_16x16x32_bf16 v[32:35], a[8:11], v[88:91], v[32:35]
    v_mfma_f32_16x16x32_bf16 v[36:39], a[72:75], v[88:91], v[36:39]
    v_mfma_f32_16x16x32_bf16 v[40:43], a[8:11], v[92:95], v[40:43]
    v_mfma_f32_16x16x32_bf16 v[44:47], a[72:75], v[92:95], v[44:47]
    ds_read_b128 v[88:91], v4 offset:256
    ds_read_b128 v[92:95], v4 offset:16640
    ds_read_b64_tr_b16 v[104:105], v8 offset:16384
    ds_read_b64_tr_b16 v[106:107], v8 offset:16896
    s_waitcnt lgkmcnt(4)
    v_mfma_f32_16x16x32_bf16 v[80:83], v[108:111], v[96:99], v[80:83]
    s_add_u32 s4, s93, 3072
    v_mfma_f32_16x16x32_bf16 v[84:87], v[108:111], v[100:103], v[84:87]
    s_add_u32 s92, s94, 3072
    v_mfma_f32_16x16x32_bf16 v[48:51], a[140:143], v[96:99], v[48:51]
    s_mov_b32 m0, s4
    v_mfma_f32_16x16x32_bf16 v[52:55], a[204:207], v[96:99], v[52:55]
    buffer_load_dwordx4 v23, s[12:15], s92 offen lds
    v_mfma_f32_16x16x32_bf16 v[56:59], a[140:143], v[100:103], v[56:59]
    s_add_u32 s4, s93, 19456
    v_mfma_f32_16x16x32_bf16 v[60:63], a[204:207], v[100:103], v[60:63]
    s_add_u32 s92, s94, 19456
    v_mfma_f32_16x16x32_bf16 v[64:67], v[96:99], v[140:143], v[64:67]
    s_mov_b32 m0, s4
    v_mfma_f32_16x16x32_bf16 v[72:75], v[96:99], v[204:207], v[72:75]
    buffer_load_dwordx4 v23, s[12:15], s92 offen lds
    v_mfma_f32_16x16x32_bf16 v[68:71], v[100:103], v[140:143], v[68:71]
    v_mfma_f32_16x16x32_bf16 v[76:79], v[100:103], v[204:207], v[76:79]
    v_mfma_f32_16x16x32_bf16 v[32:35], a[12:15], v[96:99], v[32:35]
    v_mfma_f32_16x16x32_bf16 v[36:39], a[76:79], v[96:99], v[36:39]
    v_mfma_f32_16x16x32_bf16 v[40:43], a[12:15], v[100:103], v[40:43]
    v_mfma_f32_16x16x32_bf16 v[44:47], a[76:79], v[100:103], v[44:47]
    ds_read_b128 v[96:99], v5 offset:256
    ds_read_b128 v[100:103], v5 offset:16640
    ds_read_b64_tr_b16 v[108:109], v8 offset:20480
    ds_read_b64_tr_b16 v[110:111], v8 offset:20992
    s_waitcnt lgkmcnt(4)
    v_mfma_f32_16x16x32_bf16 v[80:83], v[104:107], v[88:91], v[80:83]
    v_mfma_f32_16x16x32_bf16 v[84:87], v[104:107], v[92:95], v[84:87]
    v_mfma_f32_16x16x32_bf16 v[48:51], a[144:147], v[88:91], v[48:51]
    v_mfma_f32_16x16x32_bf16 v[52:55], a[208:211], v[88:91], v[52:55]
    v_mfma_f32_16x16x32_bf16 v[56:59], a[144:147], v[92:95], v[56:59]
    v_mfma_f32_16x16x32_bf16 v[60:63], a[208:211], v[92:95], v[60:63]
    v_mfma_f32_16x16x32_bf16 v[64:67], v[88:91], v[144:147], v[64:67]
    v_mfma_f32_16x16x32_bf16 v[72:75], v[88:91], v[208:211], v[72:75]
    v_mfma_f32_16x16x32_bf16 v[68:71], v[92:95], v[144:147], v[68:71]
    v_mfma_f32_16x16x32_bf16 v[76:79], v[92:95], v[208:211], v[76:79]
    v_mfma_f32_16x16x32_bf16 v[32:35], a[16:19], v[88:91], v[32:35]
    v_mfma_f32_16x16x32_bf16 v[36:39], a[80:83], v[88:91], v[36:39]
    v_mfma_f32_16x16x32_bf16 v[40:43], a[16:19], v[92:95], v[40:43]
    v_mfma_f32_16x16x32_bf16 v[44:47], a[80:83], v[92:95], v[44:47]
    ds_read_b128 v[88:91], v6 offset:256
    ds_read_b128 v[92:95], v6 offset:16640
    ds_read_b64_tr_b16 v[104:105], v8 offset:24576
    ds_read_b64_tr_b16 v[106:107], v8 offset:25088
    s_waitcnt lgkmcnt(4)
    v_mfma_f32_16x16x32_bf16 v[80:83], v[108:111], v[96:99], v[80:83]
    v_mfma_f32_16x16x32_bf16 v[84:87], v[108:111], v[100:103], v[84:87]
    v_mfma_f32_16x16x32_bf16 v[48:51], a[148:151], v[96:99], v[48:51]
    v_mfma_f32_16x16x32_bf16 v[52:55], a[212:215], v[96:99], v[52:55]
    v_mfma_f32_16x16x32_bf16 v[56:59], a[148:151], v[100:103], v[56:59]
    v_mfma_f32_16x16x32_bf16 v[60:63], a[212:215], v[100:103], v[60:63]
    v_mfma_f32_16x16x32_bf16 v[64:67], v[96:99], v[148:151], v[64:67]
    v_mfma_f32_16x16x32_bf16 v[72:75], v[96:99], v[212:215], v[72:75]
    v_mfma_f32_16x16x32_bf16 v[68:71], v[100:103], v[148:151], v[68:71]
    v_mfma_f32_16x16x32_bf16 v[76:79], v[100:103], v[212:215], v[76:79]
    v_mfma_f32_16x16x32_bf16 v[32:35], a[20:23], v[96:99], v[32:35]
    v_mfma_f32_16x16x32_bf16 v[36:39], a[84:87], v[96:99], v[36:39]
    v_mfma_f32_16x16x32_bf16 v[40:43], a[20:23], v[100:103], v[40:43]
    v_mfma_f32_16x16x32_bf16 v[44:47], a[84:87], v[100:103], v[44:47]
    ds_read_b128 v[96:99], v7 offset:256
    ds_read_b128 v[100:103], v7 offset:16640
    ds_read_b64_tr_b16 v[108:109], v8 offset:28672
    ds_read_b64_tr_b16 v[110:111], v8 offset:29184
    s_waitcnt lgkmcnt(4)
    v_mfma_f32_16x16x32_bf16 v[80:83], v[104:107], v[88:91], v[80:83]
    v_mfma_f32_16x16x32_bf16 v[84:87], v[104:107], v[92:95], v[84:87]
    v_mfma_f32_16x16x32_bf16 v[48:51], a[152:155], v[88:91], v[48:51]
    v_mfma_f32_16x16x32_bf16 v[52:55], a[216:219], v[88:91], v[52:55]
    v_mfma_f32_16x16x32_bf16 v[56:59], a[152:155], v[92:95], v[56:59]
    v_mfma_f32_16x16x32_bf16 v[60:63], a[216:219], v[92:95], v[60:63]
    v_mfma_f32_16x16x32_bf16 v[64:67], v[88:91], v[152:155], v[64:67]
    v_mfma_f32_16x16x32_bf16 v[72:75], v[88:91], v[216:219], v[72:75]
    v_mfma_f32_16x16x32_bf16 v[68:71], v[92:95], v[152:155], v[68:71]
    v_mfma_f32_16x16x32_bf16 v[76:79], v[92:95], v[216:219], v[76:79]
    v_mfma_f32_16x16x32_bf16 v[32:35], a[24:27], v[88:91], v[32:35]
    v_mfma_f32_16x16x32_bf16 v[36:39], a[88:91], v[88:91], v[36:39]
    v_mfma_f32_16x16x32_bf16 v[40:43], a[24:27], v[92:95], v[40:43]
    v_mfma_f32_16x16x32_bf16 v[44:47], a[88:91], v[92:95], v[44:47]
    s_waitcnt vmcnt(8)
    s_barrier
    s_cmp_lt_i32 s96, 0
    s_cbranch_scc1 L_nofl_3
    s_lshl_b32 s92, s96, 7
    s_lshl_b32 s93, s65, 2
    s_add_u32 s92, s92, s93
    s_add_u32 s92, s92, 0x81a0000
    v_mov_b32 v112, 1
    buffer_store_dword v112, v25, s[8:11], s92 offen sc1
L_nofl_3:
    ds_read_b128 v[88:91], v4 offset:512
    ds_read_b128 v[92:95], v4 offset:16896
    ds_read_b64_tr_b16 v[104:105], v8 offset:32768
    ds_read_b64_tr_b16 v[106:107], v8 offset:33280
    s_waitcnt lgkmcnt(4)
    v_mfma_f32_16x16x32_bf16 v[80:83], v[108:111], v[96:99], v[80:83]
    v_mfma_f32_16x16x32_bf16 v[84:87], v[108:111], v[100:103], v[84:87]
    v_mfma_f32_16x16x32_bf16 v[48:51], a[156:159], v[96:99], v[48:51]
    v_mfma_f32_16x16x32_bf16 v[52:55], a[220:223], v[96:99], v[52:55]
    v_mfma_f32_16x16x32_bf16 v[56:59], a[156:159], v[100:103], v[56:59]
    v_mfma_f32_16x16x32_bf16 v[60:63], a[220:223], v[100:103], v[60:63]
    v_mfma_f32_16x16x32_bf16 v[64:67], v[96:99], v[156:159], v[64:67]
    v_mfma_f32_16x16x32_bf16 v[72:75], v[96:99], v[220:223], v[72:75]
    v_mfma_f32_16x16x32_bf16 v[68:71], v[100:103], v[156:159], v[68:71]
    v_mfma_f32_16x16x32_bf16 v[76:79], v[100:103], v[220:223], v[76:79]
    v_mfma_f32_16x16x32_bf16 v[32:35], a[28:31], v[96:99], v[32:35]
    v_mfma_f32_16x16x32_bf16 v[36:39], a[92:95], v[96:99], v[36:39]
    v_mfma_f32_16x16x32_bf16 v[40:43], a[28:31], v[100:103], v[40:43]
    v_mfma_f32_16x16x32_bf16 v[44:47], a[92:95], v[100:103], v[44:47]
    ds_read_b128 v[96:99], v5 offset:512
    ds_read_b128 v[100:103], v5 offset:16896
    ds_read_b64_tr_b16 v[108:109], v8 offset:36864
    ds_read_b64_tr_b16 v[110:111], v8 offset:37376
    s_waitcnt lgkmcnt(4)
    v_mfma_f32_16x16x32_bf16 v[80:83], v[104:107], v[88:91], v[80:83]
    v_mfma_f32_16x16x32_bf16 v[84:87], v[104:107], v[92:95], v[84:87]
    v_mfma_f32_16x16x32_bf16 v[48:51], a[160:163], v[88:91], v[48:51]
    v_mfma_f32_16x16x32_bf16 v[52:55], a[224:227], v[88:91], v[52:55]
    v_mfma_f32_16x16x32_bf16 v[56:59], a[160:163], v[92:95], v[56:59]
    v_mfma_f32_16x16x32_bf16 v[60:63], a[224:227], v[92:95], v[60:63]
    v_mfma_f32_16x16x32_bf16 v[64:67], v[88:91], v[160:163], v[64:67]
    v_mfma_f32_16x16x32_bf16 v[72:75], v[88:91], v[224:227], v[72:75]
    v_mfma_f32_16x16x32_bf16 v[68:71], v[92:95], v[160:163], v[68:71]
    v_mfma_f32_16x16x32_bf16 v[76:79], v[92:95], v[224:227], v[76:79]
    v_mfma_f32_16x16x32_bf16 v[32:35], a[32:35], v[88:91], v[32:35]
    v_mfma_f32_16x16x32_bf16 v[36:39], a[96:99], v[88:91], v[36:39]
    v_mfma_f32_16x16x32_bf16 v[40:43], a[32:35], v[92:95], v[40:43]
    v_mfma_f32_16x16x32_bf16 v[44:47], a[96:99], v[92:95], v[44:47]
    ds_read_b128 v[88:91], v6 offset:512
    ds_read_b128 v[92:95], v6 offset:16896
    ds_read_b64_tr_b16 v[104:105], v8 offset:40960
    ds_read_b64_tr_b16 v[106:107], v8 offset:41472
    s_waitcnt lgkmcnt(4)
    v_mfma_f32_16x16x32_bf16 v[80:83], v[108:111], v[96:99], v[80:83]
    v_mfma_f32_16x16x32_bf16 v[84:87], v[108:111], v[100:103], v[84:87]
    v_mfma_f32_16x16x32_bf16 v[48:51], a[164:167], v[96:99], v[48:51]
    v_mfma_f32_16x16x32_bf16 v[52:55], a[228:231], v[96:99], v[52:55]
    v_mfma_f32_16x16x32_bf16 v[56:59], a[164:167], v[100:103], v[56:59]
    v_mfma_f32_16x16x32_bf16 v[60:63], a[228:231], v[100:103], v[60:63]
    v_mfma_f32_16x16x32_bf16 v[64:67], v[96:99], v[164:167], v[64:67]
    v_mfma_f32_16x16x32_bf16 v[72:75], v[96:99], v[228:231], v[72:75]
    v_mfma_f32_16x16x32_bf16 v[68:71], v[100:103], v[164:167], v[68:71]
    v_mfma_f32_16x16x32_bf16 v[76:79], v[100:103], v[228:231], v[76:79]
    v_mfma_f32_16x16x32_bf16 v[32:35], a[36:39], v[96:99], v[32:35]
    v_mfma_f32_16x16x32_bf16 v[36:39], a[100:103], v[96:99], v[36:39]
    v_mfma_f32_16x16x32_bf16 v[40:43], a[36:39], v[100:103], v[40:43]
    v_mfma_f32_16x16x32_bf16 v[44:47], a[100:103], v[100:103], v[44:47]
    ds_read_b128 v[96:99], v7 offset:512
    ds_read_b128 v[100:103], v7 offset:16896
    ds_read_b64_tr_b16 v[108:109], v8 offset:45056
    ds_read_b64_tr_b16 v[110:111], v8 offset:45568
    s_waitcnt lgkmcnt(4)
    v_mfma_f32_16x16x32_bf16 v[80:83], v[104:107], v[88:91], v[80:83]
    v_mfma_f32_16x16x32_bf16 v[84:87], v[104:107], v[92:95], v[84:87]
    v_mfma_f32_16x16x32_bf16 v[48:51], a[168:171], v[88:91], v[48:51]
    v_mfma_f32_16x16x32_bf16 v[52:55], a[232:235], v[88:91], v[52:55]
    v_mfma_f32_16x16x32_bf16 v[56:59], a[168:171], v[92:95], v[56:59]
    v_mfma_f32_16x16x32_bf16 v[60:63], a[232:235], v[92:95], v[60:63]
    v_mfma_f32_16x16x32_bf16 v[64:67], v[88:91], v[168:171], v[64:67]
    v_mfma_f32_16x16x32_bf16 v[72:75], v[88:91], v[232:235], v[72:75]
    v_mfma_f32_16x16x32_bf16 v[68:71], v[92:95], v[168:171], v[68:71]
    v_mfma_f32_16x16x32_bf16 v[76:79], v[92:95], v[232:235], v[76:79]
    v_mfma_f32_16x16x32_bf16 v[32:35], a[40:43], v[88:91], v[32:35]
    v_mfma_f32_16x16x32_bf16 v[36:39], a[104:107], v[88:91], v[36:39]
    v_mfma_f32_16x16x32_bf16 v[40:43], a[40:43], v[92:95], v[40:43]
    v_mfma_f32_16x16x32_bf16 v[44:47], a[104:107], v[92:95], v[44:47]
    ds_read_b128 v[88:91], v4 offset:768
    ds_read_b128 v[92:95], v4 offset:17152
    ds_read_b64_tr_b16 v[104:105], v8 offset:49152
    ds_read_b64_tr_b16 v[106:107], v8 offset:49664
    s_waitcnt lgkmcnt(4)
    v_mfma_f32_16x16x32_bf16 v[80:83], v[108:111], v[96:99], v[80:83]
    v_mfma_f32_16x16x32_bf16 v[84:87], v[108:111], v[100:103], v[84:87]
    v_mfma_f32_16x16x32_bf16 v[48:51], a[172:175], v[96:99], v[48:51]
    v_mfma_f32_16x16x32_bf16 v[52:55], a[236:239], v[96:99], v[52:55]
    v_mfma_f32_16x16x32_bf16 v[56:59], a[172:175], v[100:103], v[56:59]
    v_mfma_f32_16x16x32_bf16 v[60:63], a[236:239], v[100:103], v[60:63]
    v_mfma_f32_16x16x32_bf16 v[64:67], v[96:99], v[172:175], v[64:67]
    v_mfma_f32_16x16x32_bf16 v[72:75], v[96:99], v[236:239], v[72:75]
    v_mfma_f32_16x16x32_bf16 v[68:71], v[100:103], v[172:175], v[68:71]
    v_mfma_f32_16x16x32_bf16 v[76:79], v[100:103], v[236:239], v[76:79]
    v_mfma_f32_16x16x32_bf16 v[32:35], a[44:47], v[96:99], v[32:35]
    v_mfma_f32_16x16x32_bf16 v[36:39], a[108:111], v[96:99], v[36:39]
    v_mfma_f32_16x16x32_bf16 v[40:43], a[44:47], v[100:103], v[40:43]
    v_mfma_f32_16x16x32_bf16 v[44:47], a[108:111], v[100:103], v[44:47]
    ds_read_b128 v[96:99], v5 offset:768
    ds_read_b128 v[100:103], v5 offset:17152
    ds_read_b64_tr_b16 v[108:109], v8 offset:53248
    ds_read_b64_tr_b16 v[110:111], v8 offset:53760
    s_waitcnt lgkmcnt(4)
    v_mfma_f32_16x16x32_bf16 v[80:83], v[104:107], v[88:91], v[80:83]
    v_mfma_f32_16x16x32_bf16 v[84:87], v[104:107], v[92:95], v[84:87]
    v_mfma_f32_16x16x32_bf16 v[48:51], a[176:179], v[88:91], v[48:51]
    v_mfma_f32_16x16x32_bf16 v[52:55], a[240:243], v[88:91], v[52:55]
    v_mfma_f32_16x16x32_bf16 v[56:59], a[176:179], v[92:95], v[56:59]
    v_mfma_f32_16x16x32_bf16 v[60:63], a[240:243], v[92:95], v[60:63]
    v_mfma_f32_16x16x32_bf16 v[64:67], v[88:91], v[176:179], v[64:67]
    v_mfma_f32_16x16x32_bf16 v[72:75], v[88:91], v[240:243], v[72:75]
    v_mfma_f32_16x16x32_bf16 v[68:71], v[92:95], v[176:179], v[68:71]
    v_mfma_f32_16x16x32_bf16 v[76:79], v[92:95], v[240:243], v[76:79]
    v_mfma_f32_16x16x32_bf16 v[32:35], a[48:51], v[88:91], v[32:35]
    v_mfma_f32_16x16x32_bf16 v[36:39], a[112:115], v[88:91], v[36:39]
    v_mfma_f32_16x16x32_bf16 v[40:43], a[48:51], v[92:95], v[40:43]
    v_mfma_f32_16x16x32_bf16 v[44:47], a[112:115], v[92:95], v[44:47]
    ds_read_b128 v[88:91], v6 offset:768
    ds_read_b128 v[92:95], v6 offset:17152
    ds_read_b64_tr_b16 v[104:105], v8 offset:57344
    ds_read_b64_tr_b16 v[106:107], v8 offset:57856
    s_waitcnt lgkmcnt(4)
    v_mfma_f32_16x16x32_bf16 v[80:83], v[108:111], v[96:99], v[80:83]
    v_mfma_f32_16x16x32_bf16 v[84:87], v[108:111], v[100:103], v[84:87]
    v_mfma_f32_16x16x32_bf16 v[48:51], a[180:183], v[96:99], v[48:51]
    v_mfma_f32_16x16x32_bf16 v[52:55], a[244:247], v[96:99], v[52:55]
    v_mfma_f32_16x16x32_bf16 v[56:59], a[180:183], v[100:103], v[56:59]
    v_mfma_f32_16x16x32_bf16 v[60:63], a[244:247], v[100:103], v[60:63]
    v_mfma_f32_16x16x32_bf16 v[64:67], v[96:99], v[180:183], v[64:67]
    v_mfma_f32_16x16x32_bf16 v[72:75], v[96:99], v[244:247], v[72:75]
    v_mfma_f32_16x16x32_bf16 v[68:71], v[100:103], v[180:183], v[68:71]
    v_mfma_f32_16x16x32_bf16 v[76:79], v[100:103], v[244:247], v[76:79]
    v_mfma_f32_16x16x32_bf16 v[32:35], a[52:55], v[96:99], v[32:35]
    v_mfma_f32_16x16x32_bf16 v[36:39], a[116:119], v[96:99], v[36:39]
    v_mfma_f32_16x16x32_bf16 v[40:43], a[52:55], v[100:103], v[40:43]
    v_mfma_f32_16x16x32_bf16 v[44:47], a[116:119], v[100:103], v[44:47]
    ds_read_b128 v[96:99], v7 offset:768
    ds_read_b128 v[100:103], v7 offset:17152
    ds_read_b64_tr_b16 v[108:109], v8 offset:61440
    ds_read_b64_tr_b16 v[110:111], v8 offset:61952
    s_waitcnt lgkmcnt(4)
    v_mfma_f32_16x16x32_bf16 v[80:83], v[104:107], v[88:91], v[80:83]
    s_lshl_b32 s92, s29, 5
    v_mfma_f32_16x16x32_bf16 v[84:87], v[104:107], v[92:95], v[84:87]
    s_add_u32 s92, s92, s65
    v_mfma_f32_16x16x32_bf16 v[48:51], a[184:187], v[88:91], v[48:51]
    s_lshl_b32 s94, s92, 12
    v_mfma_f32_16x16x32_bf16 v[52:55], a[248:251], v[88:91], v[52:55]
    s_add_u32 s94, s94, 0x3000000
    v_mfma_f32_16x16x32_bf16 v[56:59], a[184:187], v[92:95], v[56:59]
    s_lshl_b32 s92, s92, 13
    v_mfma_f32_16x16x32_bf16 v[60:63], a[248:251], v[92:95], v[60:63]
    s_add_u32 s93, s92, s99
    v_mfma_f32_16x16x32_bf16 v[64:67], v[88:91], v[184:187], v[64:67]
    s_add_u32 s4, s93, 0x0
    v_mfma_f32_16x16x32_bf16 v[72:75], v[88:91], v[248:251], v[72:75]
    s_add_u32 s5, s4, 4096
    v_mfma_f32_16x16x32_bf16 v[68:71], v[92:95], v[184:187], v[68:71]
    s_add_u32 s6, s93, 0x2000000
    v_mfma_f32_16x16x32_bf16 v[76:79], v[92:95], v[248:251], v[76:79]
    s_add_u32 s7, s6, 4096
    v_mfma_f32_16x16x32_bf16 v[32:35], a[56:59], v[88:91], v[32:35]
    s_add_u32 s93, s93, s99
    v_mfma_f32_16x16x32_bf16 v[36:39], a[120:123], v[88:91], v[36:39]
    s_add_u32 s93, s93, 0x1000000
    v_mfma_f32_16x16x32_bf16 v[40:43], a[56:59], v[92:95], v[40:43]
    v_mfma_f32_16x16x32_bf16 v[44:47], a[120:123], v[92:95], v[44:47]
    s_waitcnt lgkmcnt(0)
    v_mfma_f32_16x16x32_bf16 v[80:83], v[108:111], v[96:99], v[80:83]
    v_mfma_f32_16x16x32_bf16 v[84:87], v[108:111], v[100:103], v[84:87]
    v_mfma_f32_16x16x32_bf16 v[48:51], a[188:191], v[96:99], v[48:51]
    v_mfma_f32_16x16x32_bf16 v[52:55], a[252:255], v[96:99], v[52:55]
    v_mfma_f32_16x16x32_bf16 v[56:59], a[188:191], v[100:103], v[56:59]
    v_mfma_f32_16x16x32_bf16 v[60:63], a[252:255], v[100:103], v[60:63]
    v_mfma_f32_16x16x32_bf16 v[64:67], v[96:99], v[188:191], v[64:67]
    v_mfma_f32_16x16x32_bf16 v[72:75], v[96:99], v[252:255], v[72:75]
    v_mfma_f32_16x16x32_bf16 v[68:71], v[100:103], v[188:191], v[68:71]
    v_mfma_f32_16x16x32_bf16 v[76:79], v[100:103], v[252:255], v[76:79]
    v_mfma_f32_16x16x32_bf16 v[32:35], a[60:63], v[96:99], v[32:35]
    v_mfma_f32_16x16x32_bf16 v[36:39], a[124:127], v[96:99], v[36:39]
    v_mfma_f32_16x16x32_bf16 v[40:43], a[60:63], v[100:103], v[40:43]
    v_mfma_f32_16x16x32_bf16 v[44:47], a[124:127], v[100:103], v[44:47]
    s_cmp_eq_u32 s64, 3
    s_cbranch_scc1 L_p1_gate
    s_mov_b32 s92, 0xbdd2d3e8
    v_mov_b32 v96, 0xc0135761
    v_mul_f32 v88, v80, v80
    v_mul_f32 v89, v81, v81
    v_mul_f32 v90, v82, v82
    v_mul_f32 v91, v83, v83
    v_mul_f32 v92, v84, v84
    v_mul_f32 v93, v85, v85
    v_mul_f32 v94, v86, v86
    v_mul_f32 v95, v87, v87
    v_cvt_pk_bf16_f32 v112, v48, v52
    v_cvt_pk_bf16_f32 v113, v49, v53
    v_cvt_pk_bf16_f32 v114, v50, v54
    v_cvt_pk_bf16_f32 v115, v51, v55
    buffer_store_dwordx4 v[112:115], v1, s[8:11], s4 offen sc1
    v_fma_f32 v88, v88, s92, v96
    v_fma_f32 v89, v89, s92, v96
    v_fma_f32 v90, v90, s92, v96
    v_fma_f32 v91, v91, s92, v96
    v_fma_f32 v92, v92, s92, v96
    v_fma_f32 v93, v93, s92, v96
    v_fma_f32 v94, v94, s92, v96
    v_fma_f32 v95, v95, s92, v96
    v_cvt_pk_bf16_f32 v116, v56, v60
    v_cvt_pk_bf16_f32 v117, v57, v61
    v_cvt_pk_bf16_f32 v118, v58, v62
    v_cvt_pk_bf16_f32 v119, v59, v63
    buffer_store_dwordx4 v[116:119], v1, s[8:11], s5 offen sc1
    v_mul_f32 v88, v88, v80
    v_mul_f32 v89, v89, v81
    v_mul_f32 v90, v90, v82
    v_mul_f32 v91, v91, v83
    v_mul_f32 v92, v92, v84
    v_mul_f32 v93, v93, v85
    v_mul_f32 v94, v94, v86
    v_mul_f32 v95, v95, v87
    v_cvt_pk_bf16_f32 v120, v64, v65
    v_cvt_pk_bf16_f32 v121, v66, v67
    v_cvt_pk_bf16_f32 v122, v68, v69
    v_cvt_pk_bf16_f32 v123, v70, v71
    buffer_store_dwordx4 v[120:123], v1, s[8:11], s93 offen offset:0 sc1
    v_exp_f32 v88, v88
    v_exp_f32 v89, v89
    v_exp_f32 v90, v90
    v_exp_f32 v91, v91
    v_exp_f32 v92, v92
    v_exp_f32 v93, v93
    v_exp_f32 v94, v94
    v_exp_f32 v95, v95
    v_cvt_pk_bf16_f32 v124, v72, v73
    v_cvt_pk_bf16_f32 v125, v74, v75
    v_cvt_pk_bf16_f32 v126, v76, v77
    v_cvt_pk_bf16_f32 v127, v78, v79
    buffer_store_dwordx4 v[124:127], v1, s[8:11], s93 offen offset:1024 sc1
    v_add_f32 v88, 1.0, v88
    v_add_f32 v89, 1.0, v89
    v_add_f32 v90, 1.0, v90
    v_add_f32 v91, 1.0, v91
    v_add_f32 v92, 1.0, v92
    v_add_f32 v93, 1.0, v93
    v_add_f32 v94, 1.0, v94
    v_add_f32 v95, 1.0, v95
    v_cvt_pk_bf16_f32 v112, v32, v36
    v_cvt_pk_bf16_f32 v113, v33, v37
    v_cvt_pk_bf16_f32 v114, v34, v38
    v_cvt_pk_bf16_f32 v115, v35, v39
    buffer_store_dwordx4 v[112:115], v1, s[8:11], s6 offen
    v_rcp_f32 v88, v88
    v_rcp_f32 v89, v89
    v_rcp_f32 v90, v90
    v_rcp_f32 v91, v91
    v_rcp_f32 v92, v92
    v_rcp_f32 v93, v93
    v_rcp_f32 v94, v94
    v_rcp_f32 v95, v95
    v_cvt_pk_bf16_f32 v116, v40, v44
    v_cvt_pk_bf16_f32 v117, v41, v45
    v_cvt_pk_bf16_f32 v118, v42, v46
    v_cvt_pk_bf16_f32 v119, v43, v47
    buffer_store_dwordx4 v[116:119], v1, s[8:11], s7 offen
    v_mul_f32 v88, v88, v80
    v_mul_f32 v89, v89, v81
    v_mul_f32 v90, v90, v82
    v_mul_f32 v91, v91, v83
    v_mul_f32 v92, v92, v84
    v_mul_f32 v93, v93, v85
    v_mul_f32 v94, v94, v86
    v_mul_f32 v95, v95, v87
    v_cvt_pk_bf16_f32 v96, v88, v89
    v_cvt_pk_bf16_f32 v97, v90, v91
    v_cvt_pk_bf16_f32 v98, v92, v93
    v_cvt_pk_bf16_f32 v99, v94, v95
    buffer_store_dwordx2 v[96:97], v24, s[8:11], s94 offen
    buffer_store_dwordx2 v[98:99], v24, s[8:11], s94 offen offset:1536
    s_branch L_p1_next
L_p1_gate:
    v_mul_f32 v88, 0xbfb8aa3b, v80
    v_mul_f32 v89, 0xbfb8aa3b, v84
    v_exp_f32 v88, v88
    v_exp_f32 v89, v89
    v_add_f32 v88, 1.0, v88
    v_add_f32 v89, 1.0, v89
    v_rcp_f32 v88, v88
    v_rcp_f32 v89, v89
    v_cvt_pk_bf16_f32 v112, v48, v52
    v_cvt_pk_bf16_f32 v113, v49, v53
    v_cvt_pk_bf16_f32 v114, v50, v54
    v_cvt_pk_bf16_f32 v115, v51, v55
    buffer_store_dwordx4 v[112:115], v1, s[8:11], s4 offen sc1
    v_cvt_pk_bf16_f32 v116, v56, v60
    v_cvt_pk_bf16_f32 v117, v57, v61
    v_cvt_pk_bf16_f32 v118, v58, v62
    v_cvt_pk_bf16_f32 v119, v59, v63
    buffer_store_dwordx4 v[116:119], v1, s[8:11], s5 offen sc1
    v_cvt_pk_bf16_f32 v120, v64, v65
    v_cvt_pk_bf16_f32 v121, v66, v67
    v_cvt_pk_bf16_f32 v122, v68, v69
    v_cvt_pk_bf16_f32 v123, v70, v71
    buffer_store_dwordx4 v[120:123], v1, s[8:11], s93 offen offset:0 sc1
    v_cvt_pk_bf16_f32 v124, v72, v73
    v_cvt_pk_bf16_f32 v125, v74, v75
    v_cvt_pk_bf16_f32 v126, v76, v77
    v_cvt_pk_bf16_f32 v127, v78, v79
    buffer_store_dwordx4 v[124:127], v1, s[8:11], s93 offen offset:1024 sc1
    v_cvt_pk_bf16_f32 v112, v32, v36
    v_cvt_pk_bf16_f32 v113, v33, v37
    v_cvt_pk_bf16_f32 v114, v34, v38
    v_cvt_pk_bf16_f32 v115, v35, v39
    buffer_store_dwordx4 v[112:115], v1, s[8:11], s6 offen
    v_cvt_pk_bf16_f32 v116, v40, v44
    v_cvt_pk_bf16_f32 v117, v41, v45
    v_cvt_pk_bf16_f32 v118, v42, v46
    v_cvt_pk_bf16_f32 v119, v43, v47
    buffer_store_dwordx4 v[116:119], v1, s[8:11], s7 offen
    buffer_store_dword v88, v24, s[8:11], s94 offen
    buffer_store_dword v89, v24, s[8:11], s94 offen offset:256
L_p1_next:
    v_xor_b32 v4, 0x8000, v4
    v_xor_b32 v5, 0x8000, v5
    v_xor_b32 v6, 0x8000, v6
    v_xor_b32 v7, 0x8000, v7
    s_xor_b32 s95, s95, 0x8000
    s_cmp_eq_u32 s96, -1
    s_mov_b32 s96, s29
    s_cbranch_scc0 L_p1_later
    s_waitcnt vmcnt(0)
    s_barrier
    s_cmp_lt_i32 s96, 0
    s_cbranch_scc1 L_nofl_4
    s_lshl_b32 s92, s96, 7
    s_lshl_b32 s93, s65, 2
    s_add_u32 s92, s92, s93
    s_add_u32 s92, s92, 0x81a0000
    v_mov_b32 v112, 1
    buffer_store_dword v112, v25, s[8:11], s92 offen sc1
L_nofl_4:
    s_mov_b32 s96, -2
    s_cmp_lg_u32 s64, 0
    s_cbranch_scc1 L_hold_ok
    s_lshl_b32 s92, s65, 9
    s_add_u32 s92, s92, 0x8004000
L_hold:
    buffer_load_dword v112, v25, s[8:11], s92 offen sc1
    s_waitcnt vmcnt(0)
    v_cmp_eq_u32 vcc, -1, v112
    s_cbranch_vccz L_hold_ok
    s_sub_u32 s28, s28, 1
    s_cbranch_scc1 L_fail
    s_sleep 12
    s_branch L_hold
L_hold_ok:
    s_barrier
L_p1_later:
    s_mov_b32 s29, s97
    s_cmp_lt_u32 s29, 64
    s_waitcnt vmcnt(8)
    s_cbranch_scc1 L_p1
    s_waitcnt vmcnt(0)
    s_barrier
    s_cmp_lt_i32 s96, 0
    s_cbranch_scc1 L_nofl_5
    s_lshl_b32 s92, s96, 7
    s_lshl_b32 s93, s65, 2
    s_add_u32 s92, s92, s93
    s_add_u32 s92, s92, 0x81a0000
    v_mov_b32 v112, 1
    buffer_store_dword v112, v25, s[8:11], s92 offen sc1
L_nofl_5:
    s_lshl_b32 s94, s65, 17
    s_lshl_b32 s95, s64, 15
    s_add_u32 s94, s94, s95
    v_xor_b32 v96, 0, v1
    v_xor_b32 v97, 64, v1
    v_xor_b32 v98, 128, v1
    v_xor_b32 v99, 192, v1
    s_add_u32 s92, s94, 0
    s_add_u32 s93, s95, 0
    s_mov_b32 m0, s93
    s_nop 0
    buffer_load_dwordx4 v96, s[80:83], s92 offen lds
    s_add_u32 s92, s94, 1024
    s_add_u32 s93, s95, 1024
    s_mov_b32 m0, s93
    s_nop 0
    buffer_load_dwordx4 v97, s[80:83], s92 offen lds
    s_add_u32 s92, s94, 2048
    s_add_u32 s93, s95, 2048
    s_mov_b32 m0, s93
    s_nop 0
    buffer_load_dwordx4 v98, s[80:83], s92 offen lds
    s_add_u32 s92, s94, 3072
    s_add_u32 s93, s95, 3072
    s_mov_b32 m0, s93
    s_nop 0
    buffer_load_dwordx4 v99, s[80:83], s92 offen lds
    s_add_u32 s92, s94, 4096
    s_add_u32 s93, s95, 4096
    s_mov_b32 m0, s93
    s_nop 0
    buffer_load_dwordx4 v96, s[80:83], s92 offen lds
    s_add_u32 s92, s94, 5120
    s_add_u32 s93, s95, 5120
    s_mov_b32 m0, s93
    s_nop 0
    buffer_load_dwordx4 v97, s[80:83], s92 offen lds
    s_add_u32 s92, s94, 6144
    s_add_u32 s93, s95, 6144
    s_mov_b32 m0, s93
    s_nop 0
    buffer_load_dwordx4 v98, s[80:83], s92 offen lds
    s_add_u32 s92, s94, 7168
    s_add_u32 s93, s95, 7168
    s_mov_b32 m0, s93
    s_nop 0
    buffer_load_dwordx4 v99, s[80:83], s92 offen lds
    s_add_u32 s92, s94, 8192
    s_add_u32 s93, s95, 8192
    s_mov_b32 m0, s93
    s_nop 0
    buffer_load_dwordx4 v96, s[80:83], s92 offen lds
    s_add_u32 s92, s94, 9216
    s_add_u32 s93, s95, 9216
    s_mov_b32 m0, s93
    s_nop 0
    buffer_load_dwordx4 v97, s[80:83], s92 offen lds
    s_add_u32 s92, s94, 10240
    s_add_u32 s93, s95, 10240
    s_mov_b32 m0, s93
    s_nop 0
    buffer_load_dwordx4 v98, s[80:83], s92 offen lds
    s_add_u32 s92, s94, 11264
    s_add_u32 s93, s95, 11264
    s_mov_b32 m0, s93
    s_nop 0
    buffer_load_dwordx4 v99, s[80:83], s92 offen lds
    s_add_u32 s92, s94, 12288
    s_add_u32 s93, s95, 12288
    s_mov_b32 m0, s93
    s_nop 0
    buffer_load_dwordx4 v96, s[80:83], s92 offen lds
    s_add_u32 s92, s94, 13312
    s_add_u32 s93, s95, 13312
    s_mov_b32 m0, s93
    s_nop 0
    buffer_load_dwordx4 v97, s[80:83], s92 offen lds
    s_add_u32 s92, s94, 14336
    s_add_u32 s93, s95, 14336
    s_mov_b32 m0, s93
    s_nop 0
    buffer_load_dwordx4 v98, s[80:83], s92 offen lds
    s_add_u32 s92, s94, 15360
    s_add_u32 s93, s95, 15360
    s_mov_b32 m0, s93
    s_nop 0
    buffer_load_dwordx4 v99, s[80:83], s92 offen lds
    s_add_u32 s92, s94, 16384
    s_add_u32 s93, s95, 16384
    s_mov_b32 m0, s93
    s_nop 0
    buffer_load_dwordx4 v96, s[80:83], s92 offen lds
    s_add_u32 s92, s94, 17408
    s_add_u32 s93, s95, 17408
    s_mov_b32 m0, s93
    s_nop 0
    buffer_load_dwordx4 v97, s[80:83], s92 offen lds
    s_add_u32 s92, s94, 18432
    s_add_u32 s93, s95, 18432
    s_mov_b32 m0, s93
    s_nop 0
    buffer_load_dwordx4 v98, s[80:83], s92 offen lds
    s_add_u32 s92, s94, 19456
    s_add_u32 s93, s95, 19456
    s_mov_b32 m0, s93
    s_nop 0
    buffer_load_dwordx4 v99, s[80:83], s92 offen lds
    s_add_u32 s92, s94, 20480
    s_add_u32 s93, s95, 20480
    s_mov_b32 m0, s93
    s_nop 0
    buffer_load_dwordx4 v96, s[80:83], s92 offen lds
    s_add_u32 s92, s94, 21504
    s_add_u32 s93, s95, 21504
    s_mov_b32 m0, s93
    s_nop 0
    buffer_load_dwordx4 v97, s[80:83], s92 offen lds
    s_add_u32 s92, s94, 22528
    s_add_u32 s93, s95, 22528
    s_mov_b32 m0, s93
    s_nop 0
    buffer_load_dwordx4 v98, s[80:83], s92 offen lds
    s_add_u32 s92, s94, 23552
    s_add_u32 s93, s95, 23552
    s_mov_b32 m0, s93
    s_nop 0
    buffer_load_dwordx4 v99, s[80:83], s92 offen lds
    s_add_u32 s92, s94, 24576
    s_add_u32 s93, s95, 24576
    s_mov_b32 m0, s93
    s_nop 0
    buffer_load_dwordx4 v96, s[80:83], s92 offen lds
    s_add_u32 s92, s94, 25600
    s_add_u32 s93, s95, 25600
    s_mov_b32 m0, s93
    s_nop 0
    buffer_load_dwordx4 v97, s[80:83], s92 offen lds
    s_add_u32 s92, s94, 26624
    s_add_u32 s93, s95, 26624
    s_mov_b32 m0, s93
    s_nop 0
    buffer_load_dwordx4 v98, s[80:83], s92 offen lds
    s_add_u32 s92, s94, 27648
    s_add_u32 s93, s95, 27648
    s_mov_b32 m0, s93
    s_nop 0
    buffer_load_dwordx4 v99, s[80:83], s92 offen lds
    s_add_u32 s92, s94, 28672
    s_add_u32 s93, s95, 28672
    s_mov_b32 m0, s93
    s_nop 0
    buffer_load_dwordx4 v96, s[80:83], s92 offen lds
    s_add_u32 s92, s94, 29696
    s_add_u32 s93, s95, 29696
    s_mov_b32 m0, s93
    s_nop 0
    buffer_load_dwordx4 v97, s[80:83], s92 offen lds
    s_add_u32 s92, s94, 30720
    s_add_u32 s93, s95, 30720
    s_mov_b32 m0, s93
    s_nop 0
    buffer_load_dwordx4 v98, s[80:83], s92 offen lds
    s_add_u32 s92, s94, 31744
    s_add_u32 s93, s95, 31744
    s_mov_b32 m0, s93
    s_nop 0
    buffer_load_dwordx4 v99, s[80:83], s92 offen lds
    v_lshrrev_b32 v50, 4, v3
    v_bfe_u32 v51, v3, 2, 2
    v_lshl_add_u32 v52, v50, 2, v51
    v_lshlrev_b32 v52, 10, v52
    v_and_b32 v53, 3, v3
    v_lshl_or_b32 v52, v53, 4, v52
    s_lshl_b32 s4, s64, 8
    v_add_u32 v52, s4, v52
    v_xor_b32 v53, 0, v51
    v_lshl_or_b32 v100, v53, 6, v52
    v_add_u32 v104, 0x10000, v100
    v_xor_b32 v53, 1, v51
    v_lshl_or_b32 v101, v53, 6, v52
    v_add_u32 v105, 0x10000, v101
    v_xor_b32 v53, 2, v51
    v_lshl_or_b32 v102, v53, 6, v52
    v_add_u32 v106, 0x10000, v102
    v_xor_b32 v53, 3, v51
    v_lshl_or_b32 v103, v53, 6, v52
    v_add_u32 v107, 0x10000, v103
    s_waitcnt vmcnt(0)
    s_barrier
    ds_read_b64_tr_b16 a[0:1], v100 offset:0
    ds_read_b64_tr_b16 a[2:3], v100 offset:16384
    ds_read_b64_tr_b16 a[4:5], v100 offset:32768
    ds_read_b64_tr_b16 a[6:7], v100 offset:49152
    ds_read_b64_tr_b16 a[8:9], v104 offset:0
    ds_read_b64_tr_b16 a[10:11], v104 offset:16384
    ds_read_b64_tr_b16 a[12:13], v104 offset:32768
    ds_read_b64_tr_b16 a[14:15], v104 offset:49152
    s_waitcnt lgkmcnt(0)
    ds_read_b64_tr_b16 a[16:17], v100 offset:8
    ds_read_b64_tr_b16 a[18:19], v100 offset:16392
    ds_read_b64_tr_b16 a[20:21], v100 offset:32776
    ds_read_b64_tr_b16 a[22:23], v100 offset:49160
    ds_read_b64_tr_b16 a[24:25], v104 offset:8
    ds_read_b64_tr_b16 a[26:27], v104 offset:16392
    ds_read_b64_tr_b16 a[28:29], v104 offset:32776
    ds_read_b64_tr_b16 a[30:31], v104 offset:49160
    s_waitcnt lgkmcnt(0)
    ds_read_b64_tr_b16 a[32:33], v101 offset:0
    ds_read_b64_tr_b16 a[34:35], v101 offset:16384
    ds_read_b64_tr_b16 a[36:37], v101 offset:32768
    ds_read_b64_tr_b16 a[38:39], v101 offset:49152
    ds_read_b64_tr_b16 a[40:41], v105 offset:0
    ds_read_b64_tr_b16 a[42:43], v105 offset:16384
    ds_read_b64_tr_b16 a[44:45], v105 offset:32768
    ds_read_b64_tr_b16 a[46:47], v105 offset:49152
    s_waitcnt lgkmcnt(0)
    ds_read_b64_tr_b16 a[48:49], v101 offset:8
    ds_read_b64_tr_b16 a[50:51], v101 offset:16392
    ds_read_b64_tr_b16 a[52:53], v101 offset:32776
    ds_read_b64_tr_b16 a[54:55], v101 offset:49160
    ds_read_b64_tr_b16 a[56:57], v105 offset:8
    ds_read_b64_tr_b16 a[58:59], v105 offset:16392
    ds_read_b64_tr_b16 a[60:61], v105 offset:32776
    ds_read_b64_tr_b16 a[62:63], v105 offset:49160
    s_waitcnt lgkmcnt(0)
    ds_read_b64_tr_b16 a[64:65], v102 offset:0
    ds_read_b64_tr_b16 a[66:67], v102 offset:16384
    ds_read_b64_tr_b16 a[68:69], v102 offset:32768
    ds_read_b64_tr_b16 a[70:71], v102 offset:49152
    ds_read_b64_tr_b16 a[72:73], v106 offset:0
    ds_read_b64_tr_b16 a[74:75], v106 offset:16384
    ds_read_b64_tr_b16 a[76:77], v106 offset:32768
    ds_read_b64_tr_b16 a[78:79], v106 offset:49152
    s_waitcnt lgkmcnt(0)
    ds_read_b64_tr_b16 a[80:81], v102 offset:8
    ds_read_b64_tr_b16 a[82:83], v102 offset:16392
    ds_read_b64_tr_b16 a[84:85], v102 offset:32776
    ds_read_b64_tr_b16 a[86:87], v102 offset:49160
    ds_read_b64_tr_b16 a[88:89], v106 offset:8
    ds_read_b64_tr_b16 a[90:91], v106 offset:16392
    ds_read_b64_tr_b16 a[92:93], v106 offset:32776
    ds_read_b64_tr_b16 a[94:95], v106 offset:49160
    s_waitcnt lgkmcnt(0)
    ds_read_b64_tr_b16 a[96:97], v103 offset:0
    ds_read_b64_tr_b16 a[98:99], v103 offset:16384
    ds_read_b64_tr_b16 a[100:101], v103 offset:32768
    ds_read_b64_tr_b16 a[102:103], v103 offset:49152
    ds_read_b64_tr_b16 a[104:105], v107 offset:0
    ds_read_b64_tr_b16 a[106:107], v107 offset:16384
    ds_read_b64_tr_b16 a[108:109], v107 offset:32768
    ds_read_b64_tr_b16 a[110:111], v107 offset:49152
    s_waitcnt lgkmcnt(0)
    ds_read_b64_tr_b16 a[112:113], v103 offset:8
    ds_read_b64_tr_b16 a[114:115], v103 offset:16392
    ds_read_b64_tr_b16 a[116:117], v103 offset:32776
    ds_read_b64_tr_b16 a[118:119], v103 offset:49160
    ds_read_b64_tr_b16 a[120:121], v107 offset:8
    ds_read_b64_tr_b16 a[122:123], v107 offset:16392
    ds_read_b64_tr_b16 a[124:125], v107 offset:32776
    ds_read_b64_tr_b16 a[126:127], v107 offset:49160
    s_waitcnt lgkmcnt(0)
    s_barrier
    s_lshl_b32 s94, s30, 13
    s_mul_i32 s95, s64, 12288
    s_add_u32 s94, s94, s95
    s_mul_i32 s96, s64, 12
    s_lshl_b32 s97, s31, 3
    s_add_u32 s92, s94, 0
    s_add_u32 s4, s96, 0
    s_cmp_lt_u32 s4, s97
    s_cselect_b32 s92, s92, 0x40000000
    s_add_u32 s93, s95, 0
    s_mov_b32 m0, s93
    s_nop 0
    buffer_load_dwordx4 v96, s[88:91], s92 offen lds
    s_add_u32 s92, s94, 1024
    s_add_u32 s4, s96, 1
    s_cmp_lt_u32 s4, s97
    s_cselect_b32 s92, s92, 0x40000000
    s_add_u32 s93, s95, 1024
    s_mov_b32 m0, s93
    s_nop 0
    buffer_load_dwordx4 v97, s[88:91], s92 offen lds
    s_add_u32 s92, s94, 2048
    s_add_u32 s4, s96, 2
    s_cmp_lt_u32 s4, s97
    s_cselect_b32 s92, s92, 0x40000000
    s_add_u32 s93, s95, 2048
    s_mov_b32 m0, s93
    s_nop 0
    buffer_load_dwordx4 v98, s[88:91], s92 offen lds
    s_add_u32 s92, s94, 3072
    s_add_u32 s4, s96, 3
    s_cmp_lt_u32 s4, s97
    s_cselect_b32 s92, s92, 0x40000000
    s_add_u32 s93, s95, 3072
    s_mov_b32 m0, s93
    s_nop 0
    buffer_load_dwordx4 v99, s[88:91], s92 offen lds
    s_add_u32 s92, s94, 4096
    s_add_u32 s4, s96, 4
    s_cmp_lt_u32 s4, s97
    s_cselect_b32 s92, s92, 0x40000000
    s_add_u32 s93, s95, 4096
    s_mov_b32 m0, s93
    s_nop 0
    buffer_load_dwordx4 v96, s[88:91], s92 offen lds
    s_add_u32 s92, s94, 5120
    s_add_u32 s4, s96, 5
    s_cmp_lt_u32 s4, s97
    s_cselect_b32 s92, s92, 0x40000000
    s_add_u32 s93, s95, 5120
    s_mov_b32 m0, s93
    s_nop 0
    buffer_load_dwordx4 v97, s[88:91], s92 offen lds
    s_add_u32 s92, s94, 6144
    s_add_u32 s4, s96, 6
    s_cmp_lt_u32 s4, s97
    s_cselect_b32 s92, s92, 0x40000000
    s_add_u32 s93, s95, 6144
    s_mov_b32 m0, s93
    s_nop 0
    buffer_load_dwordx4 v98, s[88:91], s92 offen lds
    s_add_u32 s92, s94, 7168
    s_add_u32 s4, s96, 7
    s_cmp_lt_u32 s4, s97
    s_cselect_b32 s92, s92, 0x40000000
    s_add_u32 s93, s95, 7168
    s_mov_b32 m0, s93
    s_nop 0
    buffer_load_dwordx4 v99, s[88:91], s92 offen lds
    s_add_u32 s92, s94, 8192
    s_add_u32 s4, s96, 8
    s_cmp_lt_u32 s4, s97
    s_cselect_b32 s92, s92, 0x40000000
    s_add_u32 s93, s95, 8192
    s_mov_b32 m0, s93
    s_nop 0
    buffer_load_dwordx4 v96, s[88:91], s92 offen lds
    s_add_u32 s92, s94, 9216
    s_add_u32 s4, s96, 9
    s_cmp_lt_u32 s4, s97
    s_cselect_b32 s92, s92, 0x40000000
    s_add_u32 s93, s95, 9216
    s_mov_b32 m0, s93
    s_nop 0
    buffer_load_dwordx4 v97, s[88:91], s92 offen lds
    s_add_u32 s92, s94, 10240
    s_add_u32 s4, s96, 10
    s_cmp_lt_u32 s4, s97
    s_cselect_b32 s92, s92, 0x40000000
    s_add_u32 s93, s95, 10240
    s_mov_b32 m0, s93
    s_nop 0
    buffer_load_dwordx4 v98, s[88:91], s92 offen lds
    s_add_u32 s92, s94, 11264
    s_add_u32 s4, s96, 11
    s_cmp_lt_u32 s4, s97
    s_cselect_b32 s92, s92, 0x40000000
    s_add_u32 s93, s95, 11264
    s_mov_b32 m0, s93
    s_nop 0
    buffer_load_dwordx4 v99, s[88:91], s92 offen lds
    v_and_b32 v50, 2, v3
    v_cmp_eq_u32 vcc, 0, v50
    v_mov_b32 v50, 0xeeee
    v_mov_b32 v51, 0x4444
    v_cndmask_b32 v2, v50, v51, vcc
    v_mov_b32 v4, 0x3f803f80
    v_mov_b32 v5, 0x3f803f80
    v_mov_b32 v6, 0x3f803f80
    v_mov_b32 v7, 0x3f803f80
    v_lshrrev_b32 v50, 4, v3
    v_mul_u32_u24 v50, 576, v50
    v_and_b32 v51, 15, v3
    v_lshl_add_u32 v50, v51, 2, v50
    s_lshl_b32 s4, s64, 6
    s_add_u32 s4, s4, 0x14000
    v_add_u32 v12, s4, v50
    v_lshrrev_b32 v52, 4, v3
    v_bfe_u32 v50, v3, 2, 2
    v_and_b32 v51, 1, v3
    v_lshl_add_u32 v50, v50, 1, v51
    v_mul_u32_u24 v50, 288, v50
    v_lshl_add_u32 v50, v52, 4, v50
    v_add_u32 v13, 0x14000, v50
    v_mov_b32 v14, v100
    v_mov_b32 v15, v101
    v_mov_b32 v16, v102
    v_mov_b32 v17, v103
    v_and_b32 v50, 15, v3
    v_and_b32 v51, 1, v3
    v_lshlrev_b32 v51, 4, v51
    v_mov_b32 v52, 0x3f80
    v_lshlrev_b32 v52, v51, v52
    v_lshrrev_b32 v51, 1, v50
    v_cmp_eq_u32 vcc, 0, v51
    s_nop 1
    v_cndmask_b32 v8, 0, v52, vcc
    v_cmp_eq_u32 vcc, 1, v51
    s_nop 1
    v_cndmask_b32 v9, 0, v52, vcc
    v_cmp_eq_u32 vcc, 2, v51
    s_nop 1
    v_cndmask_b32 v10, 0, v52, vcc
    v_cmp_eq_u32 vcc, 3, v51
    s_nop 1
    v_cndmask_b32 v11, 0, v52, vcc
    v_lshrrev_b32 v51, 4, v3
    v_lshlrev_b32 v52, 2, v51
    v_sub_u32 v24, v50, v52
    v_add_u32 v18, 0xc000, v1
    s_and_b32 s4, s64, 1
    s_lshl_b32 s4, s4, 12
    v_add_u32 v19, s4, v18
    s_lshr_b32 s5, s64, 1
    s_lshl_b32 s5, s5, 12
    v_add_u32 v20, s5, v18
    v_lshlrev_b32 v50, 2, v3
    s_lshl_b32 s4, s64, 9
    s_add_u32 s4, s4, 0x14900
    v_add_u32 v21, s4, v50
    s_lshr_b32 s5, s64, 1
    s_lshl_b32 s5, s5, 10
    s_add_u32 s5, s5, 0x14900
    v_add_u32 v22, s5, v50
    s_and_b32 s4, s64, 1
    s_lshl_b32 s4, s4, 12
    s_lshr_b32 s5, s64, 1
    s_lshl_b32 s5, s5, 11
    s_add_u32 s4, s4, s5
    s_add_u32 s4, s4, 0x15100
    v_add_u32 v23, s4, v1
    v_and_b32 v50, 15, v3
    v_lshlrev_b32 v50, 4, v50
    v_lshl_or_b32 v50, v51, 10, v50
    s_lshl_b32 s4, s65, 15
    s_lshl_b32 s5, s64, 8
    s_add_u32 s4, s4, s5
    v_add_u32 v126, s4, v50
    s_and_b32 s4, s65, 15
    s_lshl_b32 s4, s4, 6
    s_lshl_b32 s5, s64, 4
    s_add_u32 s4, s4, s5
    v_lshlrev_b32 v52, 3, v51
    v_add_u32 v52, s4, v52
    v_cmp_gt_u32 vcc, 2, v51
    v_mov_b32 v53, 0x80000000
    s_nop 0
    v_cndmask_b32 v52, v53, v52, vcc
    s_mov_b32 s16, s54
    s_and_b32 s17, s55, 0xffff
    s_mov_b32 s18, 0x400
    s_mov_b32 s19, 0x20000
    buffer_load_dwordx2 v[54:55], v52, s[16:19], 0 offen
    v_and_b32 v50, 15, v3
    s_lshr_b32 s5, s65, 4
    s_lshl_b32 s5, s5, 14
    v_lshl_add_u32 v50, v50, 10, v52
    v_add_u32 v127, s5, v50
    s_waitcnt vmcnt(0)
    v_lshlrev_b32 v28, 16, v54
    v_and_b32 v29, 0xffff0000, v54
    v_lshlrev_b32 v30, 16, v55
    v_and_b32 v31, 0xffff0000, v55
    s_lshl_b32 s98, s64, 10
    s_lshl_b32 s99, s64, 11
    s_mov_b32 s29, s66
L_p3:
    s_barrier
    s_lshl_b32 s92, s29, 5
    s_add_u32 s92, s92, s65
    s_lshl_b32 s94, s92, 12
    s_add_u32 s94, s94, 0x3000000
    s_lshl_b32 s92, s92, 13
    s_add_u32 s92, s92, s99
    v_lshlrev_b32 v108, 3, v3
    v_lshlrev_b32 v109, 2, v3
    buffer_load_dwordx4 v[96:99], v1, s[8:11], s94 offen offset:0 sc1
    buffer_load_dwordx2 v[104:105], v108, s[8:11], s94 offen offset:1024 sc1
    buffer_load_dword v26, v109, s[8:11], s94 offen offset:3072 sc1
    buffer_load_dwordx4 v[100:103], v1, s[8:11], s94 offen offset:1536 sc1
    buffer_load_dwordx2 v[106:107], v108, s[8:11], s94 offen offset:2560 sc1
    buffer_load_dword v27, v109, s[8:11], s94 offen offset:3328 sc1
    s_add_u32 s93, s92, 0x2000000
    s_add_u32 s95, s99, 0xc000
    s_mov_b32 m0, s95
    s_nop 0
    buffer_load_dwordx4 v1, s[8:11], s93 offen sc1 lds
    s_mov_b32 m0, s95
    s_nop 0
    buffer_load_dwordx4 v1, s[8:11], s93 offen offset:1024 sc1 lds
    s_add_u32 s93, s92, 0x0
    s_add_u32 s95, s99, 0xe000
    s_mov_b32 m0, s95
    s_nop 0
    buffer_load_dwordx4 v1, s[8:11], s93 offen sc1 lds
    s_mov_b32 m0, s95
    s_nop 0
    buffer_load_dwordx4 v1, s[8:11], s93 offen offset:1024 sc1 lds
    s_add_u32 s93, s92, 0x1000000
    s_add_u32 s95, s99, 0x10000
    s_mov_b32 m0, s95
    s_nop 0
    buffer_load_dwordx4 v1, s[8:11], s93 offen sc1 lds
    s_mov_b32 m0, s95
    s_nop 0
    buffer_load_dwordx4 v1, s[8:11], s93 offen offset:1024 sc1 lds
    ds_read_b64_tr_b16 v[110:111], v14 offset:0
    ds_read_b64_tr_b16 v[112:113], v14 offset:16384
    ds_read_b64_tr_b16 v[114:115], v14 offset:32768
    s_waitcnt vmcnt(6)
    ds_read_b64_tr_b16 v[116:117], v14 offset:8
    ds_read_b64_tr_b16 v[118:119], v14 offset:16392
    ds_read_b64_tr_b16 v[120:121], v14 offset:32776
    s_waitcnt lgkmcnt(3)
    v_mfma_f32_16x16x32_bf16 v[32:35], v[110:113], v[96:99], 0
    v_mfma_f32_16x16x32_bf16 v[64:67], v[110:113], v[100:103], 0
    s_nop 4
    v_mfma_f32_16x16x16_bf16 v[32:35], v[114:115], v[104:105], v[32:35]
    v_mfma_f32_16x16x16_bf16 v[64:67], v[114:115], v[106:107], v[64:67]
    ds_read_b64_tr_b16 v[110:111], v15 offset:0
    ds_read_b64_tr_b16 v[112:113], v15 offset:16384
    ds_read_b64_tr_b16 v[114:115], v15 offset:32768
    s_waitcnt lgkmcnt(3)
    v_mfma_f32_16x16x32_bf16 v[36:39], v[116:119], v[96:99], 0
    v_mfma_f32_16x16x32_bf16 v[68:71], v[116:119], v[100:103], 0
    s_nop 4
    v_mfma_f32_16x16x16_bf16 v[36:39], v[120:121], v[104:105], v[36:39]
    v_mfma_f32_16x16x16_bf16 v[68:71], v[120:121], v[106:107], v[68:71]
    ds_read_b64_tr_b16 v[116:117], v15 offset:8
    ds_read_b64_tr_b16 v[118:119], v15 offset:16392
    ds_read_b64_tr_b16 v[120:121], v15 offset:32776
    s_waitcnt lgkmcnt(3)
    v_mfma_f32_16x16x32_bf16 v[40:43], v[110:113], v[96:99], 0
    v_mfma_f32_16x16x32_bf16 v[72:75], v[110:113], v[100:103], 0
    s_nop 4
    v_mfma_f32_16x16x16_bf16 v[40:43], v[114:115], v[104:105], v[40:43]
    v_mfma_f32_16x16x16_bf16 v[72:75], v[114:115], v[106:107], v[72:75]
    ds_read_b64_tr_b16 v[110:111], v16 offset:0
    ds_read_b64_tr_b16 v[112:113], v16 offset:16384
    ds_read_b64_tr_b16 v[114:115], v16 offset:32768
    s_waitcnt lgkmcnt(3)
    v_mfma_f32_16x16x32_bf16 v[44:47], v[116:119], v[96:99], 0
    v_mfma_f32_16x16x32_bf16 v[76:79], v[116:119], v[100:103], 0
    s_nop 4
    v_mfma_f32_16x16x16_bf16 v[44:47], v[120:121], v[104:105], v[44:47]
    v_mfma_f32_16x16x16_bf16 v[76:79], v[120:121], v[106:107], v[76:79]
    ds_read_b64_tr_b16 v[116:117], v16 offset:8
    ds_read_b64_tr_b16 v[118:119], v16 offset:16392
    ds_read_b64_tr_b16 v[120:121], v16 offset:32776
    s_waitcnt lgkmcnt(3)
    v_mfma_f32_16x16x32_bf16 v[48:51], v[110:113], v[96:99], 0
    v_mfma_f32_16x16x32_bf16 v[80:83], v[110:113], v[100:103], 0
    s_nop 4
    v_mfma_f32_16x16x16_bf16 v[48:51], v[114:115], v[104:105], v[48:51]
    v_mfma_f32_16x16x16_bf16 v[80:83], v[114:115], v[106:107], v[80:83]
    ds_read_b64_tr_b16 v[110:111], v17 offset:0
    ds_read_b64_tr_b16 v[112:113], v17 offset:16384
    ds_read_b64_tr_b16 v[114:115], v17 offset:32768
    s_waitcnt lgkmcnt(3)
    v_mfma_f32_16x16x32_bf16 v[52:55], v[116:119], v[96:99], 0
    v_mfma_f32_16x16x32_bf16 v[84:87], v[116:119], v[100:103], 0
    s_nop 4
    v_mfma_f32_16x16x16_bf16 v[52:55], v[120:121], v[104:105], v[52:55]
    v_mfma_f32_16x16x16_bf16 v[84:87], v[120:121], v[106:107], v[84:87]
    ds_read_b64_tr_b16 v[116:117], v17 offset:8
    ds_read_b64_tr_b16 v[118:119], v17 offset:16392
    ds_read_b64_tr_b16 v[120:121], v17 offset:32776
    s_waitcnt lgkmcnt(3)
    v_mfma_f32_16x16x32_bf16 v[56:59], v[110:113], v[96:99], 0
    v_mfma_f32_16x16x32_bf16 v[88:91], v[110:113], v[100:103], 0
    s_nop 4
    v_mfma_f32_16x16x16_bf16 v[56:59], v[114:115], v[104:105], v[56:59]
    v_mfma_f32_16x16x16_bf16 v[88:91], v[114:115], v[106:107], v[88:91]
    s_waitcnt lgkmcnt(0)
    v_mfma_f32_16x16x32_bf16 v[60:63], v[116:119], v[96:99], 0
    v_mfma_f32_16x16x32_bf16 v[92:95], v[116:119], v[100:103], 0
    s_nop 4
    v_mfma_f32_16x16x16_bf16 v[60:63], v[120:121], v[104:105], v[60:63]
    v_mfma_f32_16x16x16_bf16 v[92:95], v[120:121], v[106:107], v[92:95]
    v_sub_f32 v96, 1.0, v26
    v_sub_f32 v97, 1.0, v27
    v_mul_f32 v32, v32, v96
    v_mul_f32 v33, v33, v96
    v_mul_f32 v34, v34, v96
    v_mul_f32 v35, v35, v96
    v_mul_f32 v36, v36, v96
    v_mul_f32 v37, v37, v96
    v_mul_f32 v38, v38, v96
    v_mul_f32 v39, v39, v96
    v_mul_f32 v40, v40, v96
    v_mul_f32 v41, v41, v96
    v_mul_f32 v42, v42, v96
    v_mul_f32 v43, v43, v96
    v_mul_f32 v44, v44, v96
    v_mul_f32 v45, v45, v96
    v_mul_f32 v46, v46, v96
    v_mul_f32 v47, v47, v96
    v_mul_f32 v48, v48, v96
    v_mul_f32 v49, v49, v96
    v_mul_f32 v50, v50, v96
    v_mul_f32 v51, v51, v96
    v_mul_f32 v52, v52, v96
    v_mul_f32 v53, v53, v96
    v_mul_f32 v54, v54, v96
    v_mul_f32 v55, v55, v96
    v_mul_f32 v56, v56, v96
    v_mul_f32 v57, v57, v96
    v_mul_f32 v58, v58, v96
    v_mul_f32 v59, v59, v96
    v_mul_f32 v60, v60, v96
    v_mul_f32 v61, v61, v96
    v_mul_f32 v62, v62, v96
    v_mul_f32 v63, v63, v96
    v_mul_f32 v64, v64, v97
    v_mul_f32 v65, v65, v97
    v_mul_f32 v66, v66, v97
    v_mul_f32 v67, v67, v97
    v_mul_f32 v68, v68, v97
    v_mul_f32 v69, v69, v97
    v_mul_f32 v70, v70, v97
    v_mul_f32 v71, v71, v97
    v_mul_f32 v72, v72, v97
    v_mul_f32 v73, v73, v97
    v_mul_f32 v74, v74, v97
    v_mul_f32 v75, v75, v97
    v_mul_f32 v76, v76, v97
    v_mul_f32 v77, v77, v97
    v_mul_f32 v78, v78, v97
    v_mul_f32 v79, v79, v97
    v_mul_f32 v80, v80, v97
    v_mul_f32 v81, v81, v97
    v_mul_f32 v82, v82, v97
    v_mul_f32 v83, v83, v97
    v_mul_f32 v84, v84, v97
    v_mul_f32 v85, v85, v97
    v_mul_f32 v86, v86, v97
    v_mul_f32 v87, v87, v97
    v_mul_f32 v88, v88, v97
    v_mul_f32 v89, v89, v97
    v_mul_f32 v90, v90, v97
    v_mul_f32 v91, v91, v97
    v_mul_f32 v92, v92, v97
    v_mul_f32 v93, v93, v97
    v_mul_f32 v94, v94, v97
    v_mul_f32 v95, v95, v97
    s_lshl_b32 s92, s29, 13
    s_add_u32 s92, s92, s99
    s_lshl_b32 s92, s92, 1
    s_add_u32 s92, s92, 0x8000000
    v_and_b32 v121, 0x380, v1
    v_add_u32 v121, v121, v1
    v_mov_b64 v[104:105], 0
    v_mov_b64 v[106:107], 0
    v_mov_b64 v[108:109], 0
    v_mov_b64 v[110:111], 0
    v_mov_b64 v[112:113], 0
    v_mov_b64 v[114:115], 0
    v_mov_b64 v[116:117], 0
    v_mov_b64 v[118:119], 0
    s_cmp_eq_u32 s29, 63
    s_cbranch_scc1 L_p3_last
    s_cmp_lg_u32 s64, 0
    s_cbranch_scc1 L_p3_hint_ok
    s_lshl_b32 s93, s65, 9
    s_add_u32 s93, s93, s92
    s_branch L_p3_hint
L_p3_last:
    s_cmp_lg_u32 s64, 0
    s_cbranch_scc1 L_p3_hint_ok
    s_lshl_b32 s93, s65, 9
    s_add_u32 s93, s93, 0x80f8000
L_p3_hint:
    buffer_load_dword v96, v25, s[8:11], s93 offen sc1
    s_waitcnt vmcnt(0)
    v_cmp_eq_u32 vcc, -1, v96
    s_cbranch_vccz L_p3_hint_ok
    s_sub_u32 s28, s28, 1
    s_cbranch_scc1 L_fail
    s_sleep 3
    s_cmp_ge_u32 s29, 60
    s_cbranch_scc1 L_p3_hint
    s_sleep 24
    s_branch L_p3_hint
L_p3_hint_ok:
    s_barrier
L_p3_mem:
    buffer_load_dwordx4 v[96:99], v121, s[8:11], s92 offen sc1
    buffer_load_dwordx4 v[100:103], v121, s[8:11], s92 offen offset:2048 sc1
    s_waitcnt vmcnt(0)
    v_max3_u32 v120, v96, v97, v98
    v_max3_u32 v120, v120, v99, v100
    v_max3_u32 v120, v120, v101, v102
    v_max_u32 v120, v120, v103
    v_cmp_eq_u32 vcc, -1, v120
    s_cbranch_vccz L_p3_mem_ok
    s_sleep 2
    s_sub_u32 s28, s28, 1
    s_cbranch_scc1 L_fail
    s_branch L_p3_mem
L_p3_mem_ok:
    v_add_u32 v120, s99, v18
    s_and_b32 s93, s64, 1
    s_lshl_b32 s93, s93, 10
    v_add_u32 v121, s93, v120
    v_subrev_u32 v120, s93, v120
    ds_write_b128 v121, v[96:99] offset:24576
    ds_write_b128 v120, v[100:103] offset:25600
    s_waitcnt lgkmcnt(0)
    s_barrier
    ds_read_b128 v[96:99], v18 offset:24576
    ds_read_b128 v[100:103], v18 offset:26624
    s_waitcnt lgkmcnt(1)
    v_smfmac_f32_16x16x64_bf16 v[104:107], v[96:99], a[128:135], v2
    v_smfmac_f32_16x16x64_bf16 v[108:111], v[96:99], a[192:199], v2
    v_smfmac_f32_16x16x64_bf16 v[112:115], v[96:99], v[128:135], v2
    v_smfmac_f32_16x16x64_bf16 v[116:119], v[96:99], v[192:199], v2
    ds_read_b128 v[96:99], v18 offset:25600
    s_waitcnt lgkmcnt(1)
    v_smfmac_f32_16x16x64_bf16 v[104:107], v[100:103], a[136:143], v2
    v_smfmac_f32_16x16x64_bf16 v[108:111], v[100:103], a[200:207], v2
    v_smfmac_f32_16x16x64_bf16 v[112:115], v[100:103], v[136:143], v2
    v_smfmac_f32_16x16x64_bf16 v[116:119], v[100:103], v[200:207], v2
    ds_read_b128 v[100:103], v18 offset:27648
    s_waitcnt lgkmcnt(1)
    v_smfmac_f32_16x16x64_bf16 v[104:107], v[96:99], a[144:151], v2
    v_smfmac_f32_16x16x64_bf16 v[108:111], v[96:99], a[208:215], v2
    v_smfmac_f32_16x16x64_bf16 v[112:115], v[96:99], v[144:151], v2
    v_smfmac_f32_16x16x64_bf16 v[116:119], v[96:99], v[208:215], v2
    ds_read_b128 v[96:99], v18 offset:28672
    s_waitcnt lgkmcnt(1)
    v_smfmac_f32_16x16x64_bf16 v[104:107], v[100:103], a[152:159], v2
    v_smfmac_f32_16x16x64_bf16 v[108:111], v[100:103], a[216:223], v2
    v_smfmac_f32_16x16x64_bf16 v[112:115], v[100:103], v[152:159], v2
    v_smfmac_f32_16x16x64_bf16 v[116:119], v[100:103], v[216:223], v2
    ds_read_b128 v[100:103], v18 offset:30720
    s_waitcnt lgkmcnt(1)
    v_smfmac_f32_16x16x64_bf16 v[104:107], v[96:99], a[160:167], v2
    v_smfmac_f32_16x16x64_bf16 v[108:111], v[96:99], a[224:231], v2
    v_smfmac_f32_16x16x64_bf16 v[112:115], v[96:99], v[160:167], v2
    v_smfmac_f32_16x16x64_bf16 v[116:119], v[96:99], v[224:231], v2
    ds_read_b128 v[96:99], v18 offset:29696
    s_waitcnt lgkmcnt(1)
    v_smfmac_f32_16x16x64_bf16 v[104:107], v[100:103], a[168:175], v2
    v_smfmac_f32_16x16x64_bf16 v[108:111], v[100:103], a[232:239], v2
    v_smfmac_f32_16x16x64_bf16 v[112:115], v[100:103], v[168:175], v2
    v_smfmac_f32_16x16x64_bf16 v[116:119], v[100:103], v[232:239], v2
    ds_read_b128 v[100:103], v18 offset:31744
    s_waitcnt lgkmcnt(1)
    v_smfmac_f32_16x16x64_bf16 v[104:107], v[96:99], a[176:183], v2
    v_smfmac_f32_16x16x64_bf16 v[108:111], v[96:99], a[240:247], v2
    v_smfmac_f32_16x16x64_bf16 v[112:115], v[96:99], v[176:183], v2
    v_smfmac_f32_16x16x64_bf16 v[116:119], v[96:99], v[240:247], v2
    s_waitcnt lgkmcnt(0)
    v_smfmac_f32_16x16x64_bf16 v[104:107], v[100:103], a[184:191], v2
    v_smfmac_f32_16x16x64_bf16 v[108:111], v[100:103], a[248:255], v2
    v_smfmac_f32_16x16x64_bf16 v[112:115], v[100:103], v[184:191], v2
    v_smfmac_f32_16x16x64_bf16 v[116:119], v[100:103], v[248:255], v2
    s_nop 4
    v_add_f32 v104, v104, v106
    v_add_f32 v105, v105, v107
    v_add_f32 v108, v108, v110
    v_add_f32 v109, v109, v111
    v_cvt_pk_bf16_f32 v120, v104, v108
    v_cvt_pk_bf16_f32 v121, v105, v109
    ds_write2_b32 v12, v120, v121 offset0:0 offset1:72
    v_add_f32 v112, v112, v114
    v_add_f32 v113, v113, v115
    v_cvt_pk_bf16_f32 v122, v112, v113
    v_add_f32 v116, v116, v118
    v_add_f32 v117, v117, v119
    v_cvt_pk_bf16_f32 v123, v116, v117
    ds_write2st64_b32 v21, v122, v123 offset0:0 offset1:1
    s_waitcnt lgkmcnt(0)
    s_barrier
    s_bitcmp1_b32 s64, 0
    s_cbranch_scc1 L_p3_t1
    ds_read_b128 v[108:111], v19 offset:0
    ds_read_b128 v[112:115], v18 offset:8192
    ds_read_b128 v[116:119], v13 offset:0
    s_waitcnt lgkmcnt(1)
    v_mfma_f32_16x16x32_bf16 v[96:99], v[112:115], v[108:111], 0
    s_waitcnt lgkmcnt(0)
    v_mfma_f32_16x16x32_bf16 v[104:107], v[116:119], v[108:111], 0
    ds_read_b128 v[108:111], v19 offset:1024
    ds_read_b128 v[112:115], v18 offset:9216
    ds_read_b128 v[116:119], v13 offset:64
    s_waitcnt lgkmcnt(1)
    v_mfma_f32_16x16x32_bf16 v[96:99], v[112:115], v[108:111], v[96:99]
    s_waitcnt lgkmcnt(0)
    v_mfma_f32_16x16x32_bf16 v[104:107], v[116:119], v[108:111], v[104:107]
    ds_read_b128 v[108:111], v19 offset:2048
    ds_read_b128 v[112:115], v18 offset:10240
    ds_read_b128 v[116:119], v13 offset:128
    s_waitcnt lgkmcnt(1)
    v_mfma_f32_16x16x32_bf16 v[96:99], v[112:115], v[108:111], v[96:99]
    s_waitcnt lgkmcnt(0)
    v_mfma_f32_16x16x32_bf16 v[104:107], v[116:119], v[108:111], v[104:107]
    ds_read_b128 v[108:111], v19 offset:3072
    ds_read_b128 v[112:115], v18 offset:11264
    ds_read_b128 v[116:119], v13 offset:192
    s_waitcnt lgkmcnt(1)
    v_mfma_f32_16x16x32_bf16 v[96:99], v[112:115], v[108:111], v[96:99]
    s_waitcnt lgkmcnt(0)
    v_mfma_f32_16x16x32_bf16 v[104:107], v[116:119], v[108:111], v[104:107]
    v_mov_b32 v108, 0xff800000
    v_cmp_le_i32 vcc, 0, v24
    s_nop 3
    v_cndmask_b32 v96, v108, v96, vcc
    v_cmp_le_i32 vcc, 1, v24
    s_nop 1
    v_cndmask_b32 v97, v108, v97, vcc
    v_cmp_le_i32 vcc, 2, v24
    s_nop 1
    v_cndmask_b32 v98, v108, v98, vcc
    v_cmp_le_i32 vcc, 3, v24
    s_nop 1
    v_cndmask_b32 v99, v108, v99, vcc
    v_mov_b32 v100, v108
    v_mov_b32 v101, v108
    v_mov_b32 v102, v108
    v_mov_b32 v103, v108
    s_branch L_p3_sm
L_p3_t1:
    ds_read_b128 v[108:111], v19 offset:0
    ds_read_b128 v[112:115], v18 offset:8192
    ds_read_b128 v[116:119], v13 offset:0
    ds_read_b128 v[120:123], v18 offset:12288
    s_waitcnt lgkmcnt(2)
    v_mfma_f32_16x16x32_bf16 v[96:99], v[112:115], v[108:111], 0
    s_waitcnt lgkmcnt(1)
    v_mfma_f32_16x16x32_bf16 v[104:107], v[116:119], v[108:111], 0
    s_waitcnt lgkmcnt(0)
    v_mfma_f32_16x16x32_bf16 v[100:103], v[120:123], v[108:111], 0
    ds_read_b128 v[108:111], v19 offset:1024
    ds_read_b128 v[112:115], v18 offset:9216
    ds_read_b128 v[116:119], v13 offset:64
    ds_read_b128 v[120:123], v18 offset:13312
    s_waitcnt lgkmcnt(2)
    v_mfma_f32_16x16x32_bf16 v[96:99], v[112:115], v[108:111], v[96:99]
    s_waitcnt lgkmcnt(1)
    v_mfma_f32_16x16x32_bf16 v[104:107], v[116:119], v[108:111], v[104:107]
    s_waitcnt lgkmcnt(0)
    v_mfma_f32_16x16x32_bf16 v[100:103], v[120:123], v[108:111], v[100:103]
    ds_read_b128 v[108:111], v19 offset:2048
    ds_read_b128 v[112:115], v18 offset:10240
    ds_read_b128 v[116:119], v13 offset:128
    ds_read_b128 v[120:123], v18 offset:14336
    s_waitcnt lgkmcnt(2)
    v_mfma_f32_16x16x32_bf16 v[96:99], v[112:115], v[108:111], v[96:99]
    s_waitcnt lgkmcnt(1)
    v_mfma_f32_16x16x32_bf16 v[104:107], v[116:119], v[108:111], v[104:107]
    s_waitcnt lgkmcnt(0)
    v_mfma_f32_16x16x32_bf16 v[100:103], v[120:123], v[108:111], v[100:103]
    ds_read_b128 v[108:111], v19 offset:3072
    ds_read_b128 v[112:115], v18 offset:11264
    ds_read_b128 v[116:119], v13 offset:192
    ds_read_b128 v[120:123], v18 offset:15360
    s_waitcnt lgkmcnt(2)
    v_mfma_f32_16x16x32_bf16 v[96:99], v[112:115], v[108:111], v[96:99]
    s_waitcnt lgkmcnt(1)
    v_mfma_f32_16x16x32_bf16 v[104:107], v[116:119], v[108:111], v[104:107]
    s_waitcnt lgkmcnt(0)
    v_mfma_f32_16x16x32_bf16 v[100:103], v[120:123], v[108:111], v[100:103]
    v_mov_b32 v108, 0xff800000
    v_cmp_le_i32 vcc, 0, v24
    s_nop 5
    v_cndmask_b32 v100, v108, v100, vcc
    v_cmp_le_i32 vcc, 1, v24
    s_nop 1
    v_cndmask_b32 v101, v108, v101, vcc
    v_cmp_le_i32 vcc, 2, v24
    s_nop 1
    v_cndmask_b32 v102, v108, v102, vcc
    v_cmp_le_i32 vcc, 3, v24
    s_nop 1
    v_cndmask_b32 v103, v108, v103, vcc
L_p3_sm:
    ds_read2st64_b32 v[120:121], v22 offset0:0 offset1:1
    ds_read2st64_b32 v[122:123], v22 offset0:2 offset1:3
    ds_read_b128 v[112:115], v20 offset:16384
    ds_read_b128 v[116:119], v20 offset:17408
    v_max3_f32 v108, v96, v97, v98
    v_max3_f32 v108, v108, v99, v100
    v_max3_f32 v108, v108, v101, v102
    v_max3_f32 v108, v108, v103, v104
    v_max_f32 v108, v108, v105
    v_mov_b32 v109, v108
    s_nop 1
    v_permlane32_swap_b32 v108, v109
    v_max_f32 v108, v108, v109
    v_mov_b32 v109, v108
    s_nop 1
    v_permlane16_swap_b32 v108, v109
    v_max_f32 v108, v108, v109
    s_mov_b32 s92, 0x3e0293ee
    v_mul_f32 v108, 0xbe0293ee, v108
    v_fma_f32 v96, v96, s92, v108
    v_fma_f32 v97, v97, s92, v108
    v_fma_f32 v98, v98, s92, v108
    v_fma_f32 v99, v99, s92, v108
    v_fma_f32 v100, v100, s92, v108
    v_fma_f32 v101, v101, s92, v108
    v_fma_f32 v102, v102, s92, v108
    v_fma_f32 v103, v103, s92, v108
    v_fma_f32 v104, v104, s92, v108
    v_fma_f32 v105, v105, s92, v108
    v_exp_f32 v96, v96
    v_exp_f32 v97, v97
    v_exp_f32 v98, v98
    v_exp_f32 v99, v99
    v_exp_f32 v100, v100
    v_exp_f32 v101, v101
    v_exp_f32 v102, v102
    v_exp_f32 v103, v103
    v_exp_f32 v104, v104
    v_exp_f32 v105, v105
    s_nop 0
    v_cvt_pk_bf16_f32 v106, v104, v105
    v_mov_b32 v107, 0
    v_cvt_pk_bf16_f32 v108, v96, v97
    v_cvt_pk_bf16_f32 v109, v98, v99
    v_cvt_pk_bf16_f32 v110, v100, v101
    v_cvt_pk_bf16_f32 v111, v102, v103
    s_waitcnt lgkmcnt(0)
    s_bitcmp1_b32 s64, 0
    s_cselect_b64 vcc, -1, 0
    v_cndmask_b32 v125, v26, v27, vcc
    v_mov_b32 v104, v121
    v_mov_b32 v105, v123
    v_mfma_f32_16x16x16_bf16 v[96:99], v[120:121], v[106:107], 0
    s_nop 0
    v_mfma_f32_16x16x16_bf16 v[100:103], v[104:105], v[106:107], 0
    v_mov_b32 v104, v122
    s_nop 1
    v_mfma_f32_16x16x16_bf16 v[120:123], v[4:5], v[106:107], 0
    v_mfma_f32_16x16x32_bf16 v[96:99], v[112:115], v[108:111], v[96:99]
    s_nop 0
    v_mfma_f32_16x16x32_bf16 v[100:103], v[116:119], v[108:111], v[100:103]
    ds_read_b128 v[112:115], v20 offset:18432
    ds_read_b128 v[116:119], v20 offset:19456
    s_nop 0
    v_mfma_f32_16x16x32_bf16 v[120:123], v[4:7], v[108:111], v[120:123]
    s_nop 7
    v_rcp_f32 v124, v120
    s_nop 0
    v_mul_f32 v124, v124, v125
    v_mul_f32 v96, v96, v124
    v_mul_f32 v97, v97, v124
    v_mul_f32 v98, v98, v124
    v_mul_f32 v99, v99, v124
    v_mul_f32 v100, v100, v124
    v_mul_f32 v101, v101, v124
    v_mul_f32 v102, v102, v124
    v_mul_f32 v103, v103, v124
    v_cvt_pk_bf16_f32 v120, v96, v97
    v_cvt_pk_bf16_f32 v121, v98, v99
    v_cvt_pk_bf16_f32 v122, v100, v101
    v_cvt_pk_bf16_f32 v123, v102, v103
    ds_write_b128 v23, v[120:123] offset:0
    v_mfma_f32_16x16x16_bf16 v[96:99], v[104:105], v[106:107], 0
    v_mov_b32 v104, v105
    s_nop 1
    v_mfma_f32_16x16x16_bf16 v[100:103], v[104:105], v[106:107], 0
    s_waitcnt lgkmcnt(1)
    s_nop 0
    v_mfma_f32_16x16x32_bf16 v[96:99], v[112:115], v[108:111], v[96:99]
    s_nop 2
    v_mfma_f32_16x16x32_bf16 v[100:103], v[116:119], v[108:111], v[100:103]
    s_nop 3
    v_mul_f32 v96, v96, v124
    v_mul_f32 v97, v97, v124
    v_mul_f32 v98, v98, v124
    v_mul_f32 v99, v99, v124
    v_mul_f32 v100, v100, v124
    v_mul_f32 v101, v101, v124
    v_mul_f32 v102, v102, v124
    v_mul_f32 v103, v103, v124
    v_cvt_pk_bf16_f32 v120, v96, v97
    v_cvt_pk_bf16_f32 v121, v98, v99
    v_cvt_pk_bf16_f32 v122, v100, v101
    v_cvt_pk_bf16_f32 v123, v102, v103
    ds_write_b128 v23, v[120:123] offset:1024
    s_waitcnt lgkmcnt(0)
    s_barrier
    ds_read_b128 v[96:99], v18 offset:37120
    ds_read_b128 v[100:103], v18 offset:38144
    ds_read_b128 v[104:107], v18 offset:39168
    ds_read_b128 v[108:111], v18 offset:40192
    s_lshl_b32 s94, s29, 20
    s_add_u32 s94, s94, 0x4000000
    s_lshl_b32 s92, s64, 17
    s_lshl_b32 s93, s65, 10
    s_add_u32 s92, s92, s93
    s_add_u32 s92, s92, s94
    s_waitcnt lgkmcnt(3)
    v_mfma_f32_16x16x32_bf16 v[32:35], a[0:3], v[96:99], v[32:35]
    v_mfma_f32_16x16x32_bf16 v[36:39], a[16:19], v[96:99], v[36:39]
    s_waitcnt lgkmcnt(2)
    v_mfma_f32_16x16x32_bf16 v[32:35], a[4:7], v[100:103], v[32:35]
    v_mfma_f32_16x16x32_bf16 v[36:39], a[20:23], v[100:103], v[36:39]
    s_waitcnt lgkmcnt(1)
    v_mfma_f32_16x16x32_bf16 v[32:35], a[8:11], v[104:107], v[32:35]
    v_mfma_f32_16x16x32_bf16 v[36:39], a[24:27], v[104:107], v[36:39]
    s_waitcnt lgkmcnt(0)
    v_mfma_f32_16x16x32_bf16 v[32:35], a[12:15], v[108:111], v[32:35]
    v_mfma_f32_16x16x32_bf16 v[36:39], a[28:31], v[108:111], v[36:39]
    v_mfma_f32_16x16x32_bf16 v[40:43], a[32:35], v[96:99], v[40:43]
    v_mfma_f32_16x16x32_bf16 v[44:47], a[48:51], v[96:99], v[44:47]
    v_mfma_f32_16x16x32_bf16 v[40:43], a[36:39], v[100:103], v[40:43]
    v_mfma_f32_16x16x32_bf16 v[44:47], a[52:55], v[100:103], v[44:47]
    s_nop 2
    v_cvt_pk_bf16_f32 v112, v32, v33
    v_mfma_f32_16x16x32_bf16 v[40:43], a[40:43], v[104:107], v[40:43]
    v_cvt_pk_bf16_f32 v113, v34, v35
    v_mfma_f32_16x16x32_bf16 v[44:47], a[56:59], v[104:107], v[44:47]
    v_cvt_pk_bf16_f32 v114, v36, v37
    v_mfma_f32_16x16x32_bf16 v[40:43], a[44:47], v[108:111], v[40:43]
    v_cvt_pk_bf16_f32 v115, v38, v39
    v_mfma_f32_16x16x32_bf16 v[44:47], a[60:63], v[108:111], v[44:47]
    s_add_u32 s93, s92, 0x0
    buffer_store_dwordx4 v[112:115], v1, s[8:11], s93 offen sc1
    v_mfma_f32_16x16x32_bf16 v[48:51], a[64:67], v[96:99], v[48:51]
    v_mfma_f32_16x16x32_bf16 v[52:55], a[80:83], v[96:99], v[52:55]
    v_mfma_f32_16x16x32_bf16 v[48:51], a[68:71], v[100:103], v[48:51]
    v_mfma_f32_16x16x32_bf16 v[52:55], a[84:87], v[100:103], v[52:55]
    v_cvt_pk_bf16_f32 v116, v40, v41
    v_mfma_f32_16x16x32_bf16 v[48:51], a[72:75], v[104:107], v[48:51]
    v_cvt_pk_bf16_f32 v117, v42, v43
    v_mfma_f32_16x16x32_bf16 v[52:55], a[88:91], v[104:107], v[52:55]
    v_cvt_pk_bf16_f32 v118, v44, v45
    v_mfma_f32_16x16x32_bf16 v[48:51], a[76:79], v[108:111], v[48:51]
    v_cvt_pk_bf16_f32 v119, v46, v47
    v_mfma_f32_16x16x32_bf16 v[52:55], a[92:95], v[108:111], v[52:55]
    s_add_u32 s93, s92, 0x8000
    buffer_store_dwordx4 v[116:119], v1, s[8:11], s93 offen sc1
    v_mfma_f32_16x16x32_bf16 v[56:59], a[96:99], v[96:99], v[56:59]
    v_mfma_f32_16x16x32_bf16 v[60:63], a[112:115], v[96:99], v[60:63]
    ds_read_b128 v[96:99], v18 offset:41216
    v_mfma_f32_16x16x32_bf16 v[56:59], a[100:103], v[100:103], v[56:59]
    v_mfma_f32_16x16x32_bf16 v[60:63], a[116:119], v[100:103], v[60:63]
    v_cvt_pk_bf16_f32 v112, v48, v49
    ds_read_b128 v[100:103], v18 offset:42240
    v_mfma_f32_16x16x32_bf16 v[56:59], a[104:107], v[104:107], v[56:59]
    v_cvt_pk_bf16_f32 v113, v50, v51
    v_mfma_f32_16x16x32_bf16 v[60:63], a[120:123], v[104:107], v[60:63]
    v_cvt_pk_bf16_f32 v114, v52, v53
    ds_read_b128 v[104:107], v18 offset:43264
    v_mfma_f32_16x16x32_bf16 v[56:59], a[108:111], v[108:111], v[56:59]
    v_cvt_pk_bf16_f32 v115, v54, v55
    v_mfma_f32_16x16x32_bf16 v[60:63], a[124:127], v[108:111], v[60:63]
    s_add_u32 s93, s92, 0x10000
    buffer_store_dwordx4 v[112:115], v1, s[8:11], s93 offen sc1
    ds_read_b128 v[108:111], v18 offset:44288
    s_waitcnt lgkmcnt(3)
    v_mfma_f32_16x16x32_bf16 v[64:67], a[0:3], v[96:99], v[64:67]
    v_mfma_f32_16x16x32_bf16 v[68:71], a[16:19], v[96:99], v[68:71]
    s_waitcnt lgkmcnt(2)
    v_mfma_f32_16x16x32_bf16 v[64:67], a[4:7], v[100:103], v[64:67]
    v_mfma_f32_16x16x32_bf16 v[68:71], a[20:23], v[100:103], v[68:71]
    v_cvt_pk_bf16_f32 v116, v56, v57
    s_waitcnt lgkmcnt(1)
    v_mfma_f32_16x16x32_bf16 v[64:67], a[8:11], v[104:107], v[64:67]
    v_cvt_pk_bf16_f32 v117, v58, v59
    v_mfma_f32_16x16x32_bf16 v[68:71], a[24:27], v[104:107], v[68:71]
    v_cvt_pk_bf16_f32 v118, v60, v61
    s_waitcnt lgkmcnt(0)
    v_mfma_f32_16x16x32_bf16 v[64:67], a[12:15], v[108:111], v[64:67]
    v_cvt_pk_bf16_f32 v119, v62, v63
    v_mfma_f32_16x16x32_bf16 v[68:71], a[28:31], v[108:111], v[68:71]
    s_add_u32 s93, s92, 0x18000
    buffer_store_dwordx4 v[116:119], v1, s[8:11], s93 offen sc1
    v_mfma_f32_16x16x32_bf16 v[72:75], a[32:35], v[96:99], v[72:75]
    v_mfma_f32_16x16x32_bf16 v[76:79], a[48:51], v[96:99], v[76:79]
    v_mfma_f32_16x16x32_bf16 v[72:75], a[36:39], v[100:103], v[72:75]
    v_mfma_f32_16x16x32_bf16 v[76:79], a[52:55], v[100:103], v[76:79]
    v_cvt_pk_bf16_f32 v112, v64, v65
    v_mfma_f32_16x16x32_bf16 v[72:75], a[40:43], v[104:107], v[72:75]
    v_cvt_pk_bf16_f32 v113, v66, v67
    v_mfma_f32_16x16x32_bf16 v[76:79], a[56:59], v[104:107], v[76:79]
    v_cvt_pk_bf16_f32 v114, v68, v69
    v_mfma_f32_16x16x32_bf16 v[72:75], a[44:47], v[108:111], v[72:75]
    v_cvt_pk_bf16_f32 v115, v70, v71
    v_mfma_f32_16x16x32_bf16 v[76:79], a[60:63], v[108:111], v[76:79]
    s_add_u32 s93, s92, 0x80000
    buffer_store_dwordx4 v[112:115], v1, s[8:11], s93 offen sc1
    v_mfma_f32_16x16x32_bf16 v[80:83], a[64:67], v[96:99], v[80:83]
    v_mfma_f32_16x16x32_bf16 v[84:87], a[80:83], v[96:99], v[84:87]
    v_mfma_f32_16x16x32_bf16 v[80:83], a[68:71], v[100:103], v[80:83]
    v_mfma_f32_16x16x32_bf16 v[84:87], a[84:87], v[100:103], v[84:87]
    v_cvt_pk_bf16_f32 v116, v72, v73
    v_mfma_f32_16x16x32_bf16 v[80:83], a[72:75], v[104:107], v[80:83]
    v_cvt_pk_bf16_f32 v117, v74, v75
    v_mfma_f32_16x16x32_bf16 v[84:87], a[88:91], v[104:107], v[84:87]
    v_cvt_pk_bf16_f32 v118, v76, v77
    v_mfma_f32_16x16x32_bf16 v[80:83], a[76:79], v[108:111], v[80:83]
    v_cvt_pk_bf16_f32 v119, v78, v79
    v_mfma_f32_16x16x32_bf16 v[84:87], a[92:95], v[108:111], v[84:87]
    s_add_u32 s93, s92, 0x88000
    buffer_store_dwordx4 v[116:119], v1, s[8:11], s93 offen sc1
    v_mfma_f32_16x16x32_bf16 v[88:91], a[96:99], v[96:99], v[88:91]
    v_mfma_f32_16x16x32_bf16 v[92:95], a[112:115], v[96:99], v[92:95]
    v_mfma_f32_16x16x32_bf16 v[88:91], a[100:103], v[100:103], v[88:91]
    v_mfma_f32_16x16x32_bf16 v[92:95], a[116:119], v[100:103], v[92:95]
    v_cvt_pk_bf16_f32 v112, v80, v81
    v_mfma_f32_16x16x32_bf16 v[88:91], a[104:107], v[104:107], v[88:91]
    v_cvt_pk_bf16_f32 v113, v82, v83
    v_mfma_f32_16x16x32_bf16 v[92:95], a[120:123], v[104:107], v[92:95]
    v_cvt_pk_bf16_f32 v114, v84, v85
    v_mfma_f32_16x16x32_bf16 v[88:91], a[108:111], v[108:111], v[88:91]
    v_cvt_pk_bf16_f32 v115, v86, v87
    v_mfma_f32_16x16x32_bf16 v[92:95], a[124:127], v[108:111], v[92:95]
    s_add_u32 s93, s92, 0x90000
    buffer_store_dwordx4 v[112:115], v1, s[8:11], s93 offen sc1
    s_nop 3
    v_cvt_pk_bf16_f32 v116, v88, v89
    v_cvt_pk_bf16_f32 v117, v90, v91
    v_cvt_pk_bf16_f32 v118, v92, v93
    v_cvt_pk_bf16_f32 v119, v94, v95
    s_add_u32 s93, s92, 0x98000
    buffer_store_dwordx4 v[116:119], v1, s[8:11], s93 offen sc1
    s_cmp_ge_u32 s29, 57
    s_cbranch_scc1 L_p3_of_ok
    s_cmp_lt_u32 s29, 50
    s_cbranch_scc1 L_p3_nopoi
    v_mov_b32 v96, -1
    v_mov_b32 v97, -1
    v_mov_b32 v98, -1
    v_mov_b32 v99, -1
    s_add_u32 s93, s94, 0x700000
    buffer_store_dwordx4 v[96:99], v126, s[8:11], s93 offen sc1
    s_add_u32 s93, s94, 0x701000
    buffer_store_dwordx4 v[96:99], v126, s[8:11], s93 offen sc1
    s_add_u32 s93, s94, 0x702000
    buffer_store_dwordx4 v[96:99], v126, s[8:11], s93 offen sc1
    s_add_u32 s93, s94, 0x703000
    buffer_store_dwordx4 v[96:99], v126, s[8:11], s93 offen sc1
    s_add_u32 s93, s94, 0x704000
    buffer_store_dwordx4 v[96:99], v126, s[8:11], s93 offen sc1
    s_add_u32 s93, s94, 0x705000
    buffer_store_dwordx4 v[96:99], v126, s[8:11], s93 offen sc1
    s_add_u32 s93, s94, 0x706000
    buffer_store_dwordx4 v[96:99], v126, s[8:11], s93 offen sc1
    s_add_u32 s93, s94, 0x707000
    buffer_store_dwordx4 v[96:99], v126, s[8:11], s93 offen sc1
L_p3_nopoi:
    s_lshl_b32 s95, s29, 7
    s_add_u32 s95, s95, 0x81a4000
    s_lshl_b32 s93, s65, 2
    s_add_u32 s93, s93, s95
    s_waitcnt vmcnt(0)
    s_barrier
    v_mov_b32 v96, 1
    buffer_store_dword v96, v25, s[8:11], s93 offen sc1
    v_and_b32 v97, 31, v3
    v_lshlrev_b32 v97, 2, v97
L_p3_of:
    buffer_load_dword v96, v97, s[8:11], s95 offen sc1
    s_waitcnt vmcnt(0)
    v_cmp_eq_u32 vcc, -1, v96
    s_cbranch_vccz L_p3_of_ok
    s_sleep 1
    s_sub_u32 s28, s28, 1
    s_cbranch_scc1 L_fail
    s_branch L_p3_of
L_p3_of_ok:
    s_add_u32 s93, s94, 0
    buffer_load_dwordx4 v[32:35], v126, s[8:11], s93 offen sc1
    s_add_u32 s93, s94, 4096
    buffer_load_dwordx4 v[36:39], v126, s[8:11], s93 offen sc1
    s_add_u32 s93, s94, 8192
    buffer_load_dwordx4 v[40:43], v126, s[8:11], s93 offen sc1
    s_add_u32 s93, s94, 12288
    buffer_load_dwordx4 v[44:47], v126, s[8:11], s93 offen sc1
    s_add_u32 s93, s94, 16384
    buffer_load_dwordx4 v[48:51], v126, s[8:11], s93 offen sc1
    s_add_u32 s93, s94, 20480
    buffer_load_dwordx4 v[52:55], v126, s[8:11], s93 offen sc1
    s_add_u32 s93, s94, 24576
    buffer_load_dwordx4 v[56:59], v126, s[8:11], s93 offen sc1
    s_add_u32 s93, s94, 28672
    buffer_load_dwordx4 v[60:63], v126, s[8:11], s93 offen sc1
    s_cmp_ge_u32 s65, 16
    s_cselect_b64 vcc, -1, 0
    v_cndmask_b32 v100, v26, v27, vcc
    v_sub_f32 v100, 1.0, v100
    v_mul_f32 v96, v28, v100
    v_mul_f32 v97, v29, v100
    v_mul_f32 v98, v30, v100
    v_mul_f32 v99, v31, v100
    s_waitcnt vmcnt(7)
    s_nop 0
    v_mfma_f32_16x16x32_bf16 v[96:99], v[8:11], v[32:35], v[96:99]
    v_mov_b32 v104, v32
    s_waitcnt vmcnt(6)
    v_mfma_f32_16x16x32_bf16 v[96:99], v[8:11], v[36:39], v[96:99]
    s_waitcnt vmcnt(5)
    v_mfma_f32_16x16x32_bf16 v[96:99], v[8:11], v[40:43], v[96:99]
    v_max3_u32 v104, v104, v36, v40
    s_waitcnt vmcnt(4)
    v_mfma_f32_16x16x32_bf16 v[96:99], v[8:11], v[44:47], v[96:99]
    s_waitcnt vmcnt(3)
    v_mfma_f32_16x16x32_bf16 v[96:99], v[8:11], v[48:51], v[96:99]
    v_max3_u32 v104, v104, v44, v48
    s_waitcnt vmcnt(2)
    v_mfma_f32_16x16x32_bf16 v[96:99], v[8:11], v[52:55], v[96:99]
    s_waitcnt vmcnt(1)
    v_mfma_f32_16x16x32_bf16 v[96:99], v[8:11], v[56:59], v[96:99]
    v_max3_u32 v104, v104, v52, v56
    s_waitcnt vmcnt(0)
    v_mfma_f32_16x16x32_bf16 v[96:99], v[8:11], v[60:63], v[96:99]
    v_max_u32 v104, v104, v60
    v_cmp_eq_u32 vcc, -1, v104
    s_nop 3
    s_cbranch_vccz L_p3_sum_ok
    s_sub_u32 s28, s28, 1
    s_cbranch_scc1 L_fail
    s_branch L_p3_of_ok
L_p3_sum_ok:
    s_lshl_b32 s92, s29, 15
    v_cvt_pk_bf16_f32 v102, v96, v97
    v_cvt_pk_bf16_f32 v103, v98, v99
    buffer_store_dwordx2 v[102:103], v127, s[20:23], s92 offen
    s_add_u32 s29, s29, 7
    s_cmp_lt_u32 s29, 64
    s_cbranch_scc1 L_p3
    s_endpgm
L_fail:
    v_mov_b32 v2, 0xdead
    v_mov_b32 v3, 252
    buffer_store_dword v2, v3, s[24:27], 0 offen
L_end:
L_last:
    s_endpgm
.section .rodata,"a"
.p2align 6
.amdhsa_kernel gated_mix__memory_aug_recurrent_mem_tr__dense_activation_gelu__prompt_kernel
  .amdhsa_next_free_vgpr 512
  .amdhsa_next_free_sgpr 102
  .amdhsa_accum_offset 256
  .amdhsa_group_segment_fixed_size 0
  .amdhsa_kernarg_size 128
  .amdhsa_user_sgpr_count 2
  .amdhsa_user_sgpr_kernarg_segment_ptr 1
  .amdhsa_system_sgpr_workgroup_id_x 1
.end_amdhsa_kernel
```
